```python
import torch

def _softmax(x, axis=-1):
    return torch.softmax(x, dim=axis)
def _gelu(x):
    return torch.nn.functional.gelu(x, approximate="tanh")
def _silu(x):
    return torch.nn.functional.silu(x)
def _sigmoid(x):
    return torch.sigmoid(x)
def _layernorm(x, axis=-1, eps=1e-5):
    m = x.mean(dim=axis, keepdim=True)
    v = x.var(dim=axis, keepdim=True, unbiased=False)
    return (x - m) / torch.sqrt(v + eps)
def _scatter_add(tgt, idx, src, axis=0):
    return tgt.clone().index_add_(axis, idx, src)
def _segment_sum(src, seg, n):
    out = torch.zeros((n,) + src.shape[1:], dtype=src.dtype)
    return out.index_add_(0, seg, src)
def _pad(x, pw):
    flat = tuple(v for pair in reversed(pw) for v in pair)
    return torch.nn.functional.pad(x, flat)

kernel_name = 'standalone__mha_block__prompt'

def setup_inputs():

    _w = (lambda a: (lambda t: t.to(torch.bfloat16) if t.is_floating_point() else t)(torch.as_tensor(a)))
    B, S, D, H = 1, 2048, 640, 32
    return {
        "x": _w((lambda *s: torch.randn(*s, dtype=torch.bfloat16) * 0.2)(B, S, D)),
        "wqkv": _w((lambda *s: torch.randn(*s, dtype=torch.bfloat16) * 0.2)(D, 3 * D)),
        "wo": _w((lambda *s: torch.randn(*s, dtype=torch.bfloat16) * 0.05)(D, D)),
    }

def reference(x, wqkv, wo):
    B, S, D = x.shape
    H = 32
    Dh = D // H
    qkv = (lambda x, *d: x.permute(*d))((x @ wqkv).reshape(B, S, 3, H, Dh), 2, 0, 3, 1, 4)
    q, k, v = qkv[0], qkv[1], qkv[2]
    scores = torch.einsum("bhqd,bhkd->bhqk", q, k) * (Dh ** -0.5)
    p = _softmax(scores, axis=-1)
    o = torch.einsum("bhqk,bhkd->bhqd", p, v)
    return (lambda x, *d: x.permute(*d))(o, 0, 2, 1, 3).reshape(B, S, D) @ wo
```

```asm
; @launch kernel=qkv_kernel grid=(192,1,1) block=(512,1,1) lds=148480
; @launch kernel=attn_kernel grid=(256,1,1) block=(512,1,1) lds=110848
; @launch kernel=outp_kernel grid=(256,1,1) block=(256,1,1) lds=99328
.amdgcn_target "amdgcn-amd-amdhsa--gfx950"
.text
    .globl qkv_kernel
    .p2align 8
    .type qkv_kernel,@function
qkv_kernel:
    s_cmp_ge_u32 s2, 192
    s_cbranch_scc1 Lqkv_end

    s_load_dwordx2 s[4:5], s[0:1], 0
    s_load_dwordx2 s[8:9], s[0:1], 8
    s_load_dwordx2 s[12:13], s[0:1], 40
    v_and_b32 v1, 63, v0
    v_lshrrev_b32 v2, 6, v0
    s_and_b32 s20, s2, 7
    s_lshl_b32 s20, s20, 1
    s_bfe_u32 s21, s2, 0x10003
    s_add_u32 s16, s20, s21
    s_lshr_b32 s17, s2, 4
    v_readfirstlane_b32 s18, v2
    s_mov_b32 s6, 2621440
    s_mov_b32 s7, 0x00020000
    s_mov_b32 s10, 2457600
    s_mov_b32 s11, 0x00020000
    s_mov_b32 s14, 10616832
    s_mov_b32 s15, 0x00020000
    s_and_b32 s19, s18, 3
    s_lshr_b32 s24, s18, 2
    v_lshrrev_b32 v2, 4, v1
    v_and_b32 v3, 15, v1
    v_and_b32 v4, 7, v1
    v_lshrrev_b32 v5, 3, v1

    s_add_u32 s20, s18, 0
    s_lshl_b32 s20, s20, 3
    v_add_u32 v128, s20, v5
    v_bfe_u32 v129, v128, 1, 3
    v_xor_b32 v129, v129, v4
    v_mul_u32_u24 v128, 1280, v128
    v_lshl_add_u32 v122, v129, 4, v128

    s_add_u32 s20, s18, 8
    s_lshl_b32 s20, s20, 3
    v_add_u32 v128, s20, v5
    v_bfe_u32 v129, v128, 1, 3
    v_xor_b32 v129, v129, v4
    v_mul_u32_u24 v128, 1280, v128
    v_lshl_add_u32 v123, v129, 4, v128

    s_add_u32 s20, s18, 0
    s_lshl_b32 s20, s20, 10
    v_lshl_add_u32 v128, v1, 4, s20
    v_mul_u32_u24 v129, 52429, v128
    v_lshrrev_b32 v129, 24, v129
    v_mul_u32_u24 v130, 320, v129
    v_sub_u32 v130, v128, v130
    v_lshrrev_b32 v130, 4, v130
    v_bfe_u32 v131, v129, 3, 1
    v_lshlrev_b32 v131, 1, v131
    v_xor_b32 v130, v130, v131
    v_mul_u32_u24 v129, 3840, v129
    v_lshl_add_u32 v124, v130, 4, v129

    s_add_u32 s20, s18, 8
    s_lshl_b32 s20, s20, 10
    v_lshl_add_u32 v128, v1, 4, s20
    v_mul_u32_u24 v129, 52429, v128
    v_lshrrev_b32 v129, 24, v129
    v_mul_u32_u24 v130, 320, v129
    v_sub_u32 v130, v128, v130
    v_lshrrev_b32 v130, 4, v130
    v_bfe_u32 v131, v129, 3, 1
    v_lshlrev_b32 v131, 1, v131
    v_xor_b32 v130, v130, v131
    v_mul_u32_u24 v129, 3840, v129
    v_lshl_add_u32 v125, v130, 4, v129

    s_add_u32 s20, s18, 16
    s_lshl_b32 s20, s20, 10
    v_lshl_add_u32 v128, v1, 4, s20
    v_mul_u32_u24 v129, 52429, v128
    v_lshrrev_b32 v129, 24, v129
    v_mul_u32_u24 v130, 320, v129
    v_sub_u32 v130, v128, v130
    v_lshrrev_b32 v130, 4, v130
    v_bfe_u32 v131, v129, 3, 1
    v_lshlrev_b32 v131, 1, v131
    v_xor_b32 v130, v130, v131
    v_mul_u32_u24 v129, 3840, v129
    v_lshl_add_u32 v126, v130, 4, v129

    s_cmp_ge_u32 s18, 4
    s_cselect_b32 s25, 0, -1
    s_cselect_b32 s26, 147456, 0
    s_cselect_b32 s20, 0x80000000, 0
    v_or_b32 v126, s20, v126

    s_mul_i32 s21, s16, 163840

    s_mul_i32 s22, s17, 320
    s_lshl_b32 s27, s18, 10
    s_waitcnt lgkmcnt(0)

    s_mov_b32 s28, 0
    s_add_u32 s20, s28, s27
    s_add_u32 m0, s20, 0
    buffer_load_dwordx4 v122, s[4:7], s21 offen lds

    s_add_u32 s20, s28, s27
    s_add_u32 m0, s20, 8192
    buffer_load_dwordx4 v123, s[4:7], s21 offen lds

    s_add_u32 s20, s28, s27
    s_add_u32 m0, s20, 16384
    buffer_load_dwordx4 v124, s[8:11], s22 offen lds

    s_add_u32 s20, s28, s27
    s_add_u32 m0, s20, 24576
    buffer_load_dwordx4 v125, s[8:11], s22 offen lds

    s_add_u32 s20, s28, s27
    s_add_u32 s20, s20, 32768
    s_and_b32 s20, s20, s25
    s_add_u32 m0, s20, s26
    buffer_load_dwordx4 v126, s[8:11], s22 offen lds

    s_add_u32 s28, s28, 36864
    s_add_u32 s21, s21, 128
    s_add_u32 s22, s22, 245760

    s_add_u32 s20, s28, s27
    s_add_u32 m0, s20, 0
    buffer_load_dwordx4 v122, s[4:7], s21 offen lds

    s_add_u32 s20, s28, s27
    s_add_u32 m0, s20, 8192
    buffer_load_dwordx4 v123, s[4:7], s21 offen lds

    s_add_u32 s20, s28, s27
    s_add_u32 m0, s20, 16384
    buffer_load_dwordx4 v124, s[8:11], s22 offen lds

    s_add_u32 s20, s28, s27
    s_add_u32 m0, s20, 24576
    buffer_load_dwordx4 v125, s[8:11], s22 offen lds

    s_add_u32 s20, s28, s27
    s_add_u32 s20, s20, 32768
    s_and_b32 s20, s20, s25
    s_add_u32 m0, s20, s26
    buffer_load_dwordx4 v126, s[8:11], s22 offen lds

    s_add_u32 s28, s28, 36864
    s_add_u32 s21, s21, 128
    s_add_u32 s22, s22, 245760

    s_add_u32 s20, s28, s27
    s_add_u32 m0, s20, 0
    buffer_load_dwordx4 v122, s[4:7], s21 offen lds

    s_add_u32 s20, s28, s27
    s_add_u32 m0, s20, 8192
    buffer_load_dwordx4 v123, s[4:7], s21 offen lds

    s_add_u32 s20, s28, s27
    s_add_u32 m0, s20, 16384
    buffer_load_dwordx4 v124, s[8:11], s22 offen lds

    s_add_u32 s20, s28, s27
    s_add_u32 m0, s20, 24576
    buffer_load_dwordx4 v125, s[8:11], s22 offen lds

    s_add_u32 s20, s28, s27
    s_add_u32 s20, s20, 32768
    s_and_b32 s20, s20, s25
    s_add_u32 m0, s20, s26
    buffer_load_dwordx4 v126, s[8:11], s22 offen lds

    s_add_u32 s28, s28, 36864
    s_add_u32 s21, s21, 128
    s_add_u32 s22, s22, 245760

    s_mul_i32 s20, s19, 32
    v_add_u32 v128, s20, v3
    v_add_u32 v128, 0, v128
    v_bfe_u32 v129, v128, 1, 3
    v_lshlrev_b32 v128, 7, v128
    v_xor_b32 v130, v129, v2
    v_lshl_add_u32 v104, v130, 4, v128
    v_xor_b32 v129, 4, v129
    v_xor_b32 v130, v129, v2
    v_lshl_add_u32 v105, v130, 4, v128

    s_mul_i32 s20, s19, 32
    v_add_u32 v128, s20, v3
    v_add_u32 v128, 16, v128
    v_bfe_u32 v129, v128, 1, 3
    v_lshlrev_b32 v128, 7, v128
    v_xor_b32 v130, v129, v2
    v_lshl_add_u32 v106, v130, 4, v128
    v_xor_b32 v129, 4, v129
    v_xor_b32 v130, v129, v2
    v_lshl_add_u32 v107, v130, 4, v128

    v_lshlrev_b32 v132, 3, v2
    v_bfe_u32 v131, v1, 2, 2
    v_add_u32 v132, v132, v131
    v_mul_u32_u24 v132, 320, v132
    v_and_b32 v133, 1, v2
    v_lshlrev_b32 v133, 1, v133
    v_and_b32 v131, 3, v1
    v_lshlrev_b32 v131, 2, v131
    s_mul_i32 s20, s24, 80
    v_add_u32 v131, s20, v131
    v_add_u32 v132, 16384, v132

    v_add_u32 v128, 0, v131
    v_lshrrev_b32 v129, 3, v128
    v_xor_b32 v129, v129, v133
    v_and_b32 v128, 7, v128
    v_lshl_add_u32 v128, v128, 1, v132
    v_lshl_add_u32 v108, v129, 4, v128

    v_add_u32 v128, 16, v131
    v_lshrrev_b32 v129, 3, v128
    v_xor_b32 v129, v129, v133
    v_and_b32 v128, 7, v128
    v_lshl_add_u32 v128, v128, 1, v132
    v_lshl_add_u32 v109, v129, 4, v128

    v_add_u32 v128, 32, v131
    v_lshrrev_b32 v129, 3, v128
    v_xor_b32 v129, v129, v133
    v_and_b32 v128, 7, v128
    v_lshl_add_u32 v128, v128, 1, v132
    v_lshl_add_u32 v110, v129, 4, v128

    v_add_u32 v128, 48, v131
    v_lshrrev_b32 v129, 3, v128
    v_xor_b32 v129, v129, v133
    v_and_b32 v128, 7, v128
    v_lshl_add_u32 v128, v128, 1, v132
    v_lshl_add_u32 v111, v129, 4, v128

    v_add_u32 v128, 64, v131
    v_lshrrev_b32 v129, 3, v128
    v_xor_b32 v129, v129, v133
    v_and_b32 v128, 7, v128
    v_lshl_add_u32 v128, v128, 1, v132
    v_lshl_add_u32 v112, v129, 4, v128

    v_mov_b32 v8, 0
    v_mov_b32 v9, 0
    v_mov_b32 v10, 0
    v_mov_b32 v11, 0
    v_mov_b32 v12, 0
    v_mov_b32 v13, 0
    v_mov_b32 v14, 0
    v_mov_b32 v15, 0
    v_mov_b32 v16, 0
    v_mov_b32 v17, 0
    v_mov_b32 v18, 0
    v_mov_b32 v19, 0
    v_mov_b32 v20, 0
    v_mov_b32 v21, 0
    v_mov_b32 v22, 0
    v_mov_b32 v23, 0
    v_mov_b32 v24, 0
    v_mov_b32 v25, 0
    v_mov_b32 v26, 0
    v_mov_b32 v27, 0
    v_mov_b32 v28, 0
    v_mov_b32 v29, 0
    v_mov_b32 v30, 0
    v_mov_b32 v31, 0
    v_mov_b32 v32, 0
    v_mov_b32 v33, 0
    v_mov_b32 v34, 0
    v_mov_b32 v35, 0
    v_mov_b32 v36, 0
    v_mov_b32 v37, 0
    v_mov_b32 v38, 0
    v_mov_b32 v39, 0
    v_mov_b32 v40, 0
    v_mov_b32 v41, 0
    v_mov_b32 v42, 0
    v_mov_b32 v43, 0
    v_mov_b32 v44, 0
    v_mov_b32 v45, 0
    v_mov_b32 v46, 0
    v_mov_b32 v47, 0
    s_cmp_ge_u32 s17, 8
    s_cbranch_scc1 Lqkv_vtype
    s_mov_b32 s29, 0
    s_mov_b32 s30, 36864
    s_mov_b32 s28, 110592
    s_mov_b32 s31, 0
    s_waitcnt vmcnt(10)
    s_barrier

    v_add_u32 v113, s29, v104
    v_add_u32 v114, s29, v106
    v_add_u32 v117, s29, v108
    v_add_u32 v118, s29, v109
    v_add_u32 v119, s29, v110
    v_add_u32 v120, s29, v111
    v_add_u32 v121, s29, v112
    ds_read_b128 v[48:51], v113
    ds_read_b128 v[52:55], v114
    ds_read_b64_tr_b16 v[56:57], v117 offset:0
    ds_read_b64_tr_b16 v[58:59], v117 offset:1280
    ds_read_b64_tr_b16 v[60:61], v118 offset:0
    ds_read_b64_tr_b16 v[62:63], v118 offset:1280
    ds_read_b64_tr_b16 v[64:65], v119 offset:0
    ds_read_b64_tr_b16 v[66:67], v119 offset:1280
    ds_read_b64_tr_b16 v[68:69], v120 offset:0
    ds_read_b64_tr_b16 v[70:71], v120 offset:1280
    ds_read_b64_tr_b16 v[72:73], v121 offset:0
    ds_read_b64_tr_b16 v[74:75], v121 offset:1280
Lqkv_loopa:
    s_waitcnt vmcnt(5)
    s_barrier
    s_add_u32 s20, s28, s27
    s_add_u32 m0, s20, 0
    buffer_load_dwordx4 v122, s[4:7], s21 offen lds

    s_add_u32 s20, s28, s27
    s_add_u32 m0, s20, 8192
    buffer_load_dwordx4 v123, s[4:7], s21 offen lds

    s_add_u32 s20, s28, s27
    s_add_u32 m0, s20, 16384
    buffer_load_dwordx4 v124, s[8:11], s22 offen lds

    s_add_u32 s20, s28, s27
    s_add_u32 m0, s20, 24576
    buffer_load_dwordx4 v125, s[8:11], s22 offen lds

    s_add_u32 s20, s28, s27
    s_add_u32 s20, s20, 32768
    s_and_b32 s20, s20, s25
    s_add_u32 m0, s20, s26
    buffer_load_dwordx4 v126, s[8:11], s22 offen lds

    v_add_u32 v113, s29, v105
    v_add_u32 v114, s29, v107
    v_add_u32 v117, s29, v108
    v_add_u32 v118, s29, v109
    v_add_u32 v119, s29, v110
    v_add_u32 v120, s29, v111
    v_add_u32 v121, s29, v112
    ds_read_b128 v[76:79], v113
    ds_read_b128 v[80:83], v114
    ds_read_b64_tr_b16 v[84:85], v117 offset:10240
    ds_read_b64_tr_b16 v[86:87], v117 offset:11520
    ds_read_b64_tr_b16 v[88:89], v118 offset:10240
    ds_read_b64_tr_b16 v[90:91], v118 offset:11520
    ds_read_b64_tr_b16 v[92:93], v119 offset:10240
    ds_read_b64_tr_b16 v[94:95], v119 offset:11520
    ds_read_b64_tr_b16 v[96:97], v120 offset:10240
    ds_read_b64_tr_b16 v[98:99], v120 offset:11520
    ds_read_b64_tr_b16 v[100:101], v121 offset:10240
    ds_read_b64_tr_b16 v[102:103], v121 offset:11520
    s_waitcnt lgkmcnt(12)
    v_mfma_f32_16x16x32_bf16 v[8:11], v[56:59], v[48:51], v[8:11]
    v_mfma_f32_16x16x32_bf16 v[12:15], v[60:63], v[48:51], v[12:15]
    v_mfma_f32_16x16x32_bf16 v[16:19], v[64:67], v[48:51], v[16:19]
    v_mfma_f32_16x16x32_bf16 v[20:23], v[68:71], v[48:51], v[20:23]
    v_mfma_f32_16x16x32_bf16 v[24:27], v[72:75], v[48:51], v[24:27]
    v_mfma_f32_16x16x32_bf16 v[28:31], v[56:59], v[52:55], v[28:31]
    v_mfma_f32_16x16x32_bf16 v[32:35], v[60:63], v[52:55], v[32:35]
    v_mfma_f32_16x16x32_bf16 v[36:39], v[64:67], v[52:55], v[36:39]
    v_mfma_f32_16x16x32_bf16 v[40:43], v[68:71], v[52:55], v[40:43]
    v_mfma_f32_16x16x32_bf16 v[44:47], v[72:75], v[52:55], v[44:47]
    v_add_u32 v113, s30, v104
    v_add_u32 v114, s30, v106
    v_add_u32 v117, s30, v108
    v_add_u32 v118, s30, v109
    v_add_u32 v119, s30, v110
    v_add_u32 v120, s30, v111
    v_add_u32 v121, s30, v112
    ds_read_b128 v[48:51], v113
    ds_read_b128 v[52:55], v114
    ds_read_b64_tr_b16 v[56:57], v117 offset:0
    ds_read_b64_tr_b16 v[58:59], v117 offset:1280
    ds_read_b64_tr_b16 v[60:61], v118 offset:0
    ds_read_b64_tr_b16 v[62:63], v118 offset:1280
    ds_read_b64_tr_b16 v[64:65], v119 offset:0
    ds_read_b64_tr_b16 v[66:67], v119 offset:1280
    ds_read_b64_tr_b16 v[68:69], v120 offset:0
    ds_read_b64_tr_b16 v[70:71], v120 offset:1280
    ds_read_b64_tr_b16 v[72:73], v121 offset:0
    ds_read_b64_tr_b16 v[74:75], v121 offset:1280
    s_waitcnt lgkmcnt(12)
    v_mfma_f32_16x16x32_bf16 v[8:11], v[84:87], v[76:79], v[8:11]
    v_mfma_f32_16x16x32_bf16 v[12:15], v[88:91], v[76:79], v[12:15]
    v_mfma_f32_16x16x32_bf16 v[16:19], v[92:95], v[76:79], v[16:19]
    v_mfma_f32_16x16x32_bf16 v[20:23], v[96:99], v[76:79], v[20:23]
    v_mfma_f32_16x16x32_bf16 v[24:27], v[100:103], v[76:79], v[24:27]
    v_mfma_f32_16x16x32_bf16 v[28:31], v[84:87], v[80:83], v[28:31]
    v_mfma_f32_16x16x32_bf16 v[32:35], v[88:91], v[80:83], v[32:35]
    v_mfma_f32_16x16x32_bf16 v[36:39], v[92:95], v[80:83], v[36:39]
    v_mfma_f32_16x16x32_bf16 v[40:43], v[96:99], v[80:83], v[40:43]
    v_mfma_f32_16x16x32_bf16 v[44:47], v[100:103], v[80:83], v[44:47]
    s_mov_b32 s29, s30
    s_add_u32 s30, s30, 36864
    s_cmp_eq_u32 s30, 147456
    s_cselect_b32 s30, 0, s30
    s_add_u32 s28, s28, 36864
    s_cmp_eq_u32 s28, 147456
    s_cselect_b32 s28, 0, s28
    s_add_u32 s21, s21, 128
    s_add_u32 s22, s22, 245760

    s_add_u32 s31, s31, 1
    s_cmp_lt_u32 s31, 7
    s_cbranch_scc1 Lqkv_loopa

    s_waitcnt vmcnt(5)
    s_barrier
    v_add_u32 v113, s29, v105
    v_add_u32 v114, s29, v107
    v_add_u32 v117, s29, v108
    v_add_u32 v118, s29, v109
    v_add_u32 v119, s29, v110
    v_add_u32 v120, s29, v111
    v_add_u32 v121, s29, v112
    ds_read_b128 v[76:79], v113
    ds_read_b128 v[80:83], v114
    ds_read_b64_tr_b16 v[84:85], v117 offset:10240
    ds_read_b64_tr_b16 v[86:87], v117 offset:11520
    ds_read_b64_tr_b16 v[88:89], v118 offset:10240
    ds_read_b64_tr_b16 v[90:91], v118 offset:11520
    ds_read_b64_tr_b16 v[92:93], v119 offset:10240
    ds_read_b64_tr_b16 v[94:95], v119 offset:11520
    ds_read_b64_tr_b16 v[96:97], v120 offset:10240
    ds_read_b64_tr_b16 v[98:99], v120 offset:11520
    ds_read_b64_tr_b16 v[100:101], v121 offset:10240
    ds_read_b64_tr_b16 v[102:103], v121 offset:11520
    s_waitcnt lgkmcnt(12)
    v_mfma_f32_16x16x32_bf16 v[8:11], v[56:59], v[48:51], v[8:11]
    v_mfma_f32_16x16x32_bf16 v[12:15], v[60:63], v[48:51], v[12:15]
    v_mfma_f32_16x16x32_bf16 v[16:19], v[64:67], v[48:51], v[16:19]
    v_mfma_f32_16x16x32_bf16 v[20:23], v[68:71], v[48:51], v[20:23]
    v_mfma_f32_16x16x32_bf16 v[24:27], v[72:75], v[48:51], v[24:27]
    v_mfma_f32_16x16x32_bf16 v[28:31], v[56:59], v[52:55], v[28:31]
    v_mfma_f32_16x16x32_bf16 v[32:35], v[60:63], v[52:55], v[32:35]
    v_mfma_f32_16x16x32_bf16 v[36:39], v[64:67], v[52:55], v[36:39]
    v_mfma_f32_16x16x32_bf16 v[40:43], v[68:71], v[52:55], v[40:43]
    v_mfma_f32_16x16x32_bf16 v[44:47], v[72:75], v[52:55], v[44:47]
    v_add_u32 v113, s30, v104
    v_add_u32 v114, s30, v106
    v_add_u32 v117, s30, v108
    v_add_u32 v118, s30, v109
    v_add_u32 v119, s30, v110
    v_add_u32 v120, s30, v111
    v_add_u32 v121, s30, v112
    ds_read_b128 v[48:51], v113
    ds_read_b128 v[52:55], v114
    ds_read_b64_tr_b16 v[56:57], v117 offset:0
    ds_read_b64_tr_b16 v[58:59], v117 offset:1280
    ds_read_b64_tr_b16 v[60:61], v118 offset:0
    ds_read_b64_tr_b16 v[62:63], v118 offset:1280
    ds_read_b64_tr_b16 v[64:65], v119 offset:0
    ds_read_b64_tr_b16 v[66:67], v119 offset:1280
    ds_read_b64_tr_b16 v[68:69], v120 offset:0
    ds_read_b64_tr_b16 v[70:71], v120 offset:1280
    ds_read_b64_tr_b16 v[72:73], v121 offset:0
    ds_read_b64_tr_b16 v[74:75], v121 offset:1280
    s_waitcnt lgkmcnt(12)
    v_mfma_f32_16x16x32_bf16 v[8:11], v[84:87], v[76:79], v[8:11]
    v_mfma_f32_16x16x32_bf16 v[12:15], v[88:91], v[76:79], v[12:15]
    v_mfma_f32_16x16x32_bf16 v[16:19], v[92:95], v[76:79], v[16:19]
    v_mfma_f32_16x16x32_bf16 v[20:23], v[96:99], v[76:79], v[20:23]
    v_mfma_f32_16x16x32_bf16 v[24:27], v[100:103], v[76:79], v[24:27]
    v_mfma_f32_16x16x32_bf16 v[28:31], v[84:87], v[80:83], v[28:31]
    v_mfma_f32_16x16x32_bf16 v[32:35], v[88:91], v[80:83], v[32:35]
    v_mfma_f32_16x16x32_bf16 v[36:39], v[92:95], v[80:83], v[36:39]
    v_mfma_f32_16x16x32_bf16 v[40:43], v[96:99], v[80:83], v[40:43]
    v_mfma_f32_16x16x32_bf16 v[44:47], v[100:103], v[80:83], v[44:47]
    s_mov_b32 s29, s30
    s_add_u32 s30, s30, 36864
    s_cmp_eq_u32 s30, 147456
    s_cselect_b32 s30, 0, s30
    s_add_u32 s28, s28, 36864
    s_cmp_eq_u32 s28, 147456
    s_cselect_b32 s28, 0, s28
    s_add_u32 s21, s21, 128
    s_add_u32 s22, s22, 245760

    s_waitcnt vmcnt(0)
    s_barrier
    v_add_u32 v113, s29, v105
    v_add_u32 v114, s29, v107
    v_add_u32 v117, s29, v108
    v_add_u32 v118, s29, v109
    v_add_u32 v119, s29, v110
    v_add_u32 v120, s29, v111
    v_add_u32 v121, s29, v112
    ds_read_b128 v[76:79], v113
    ds_read_b128 v[80:83], v114
    ds_read_b64_tr_b16 v[84:85], v117 offset:10240
    ds_read_b64_tr_b16 v[86:87], v117 offset:11520
    ds_read_b64_tr_b16 v[88:89], v118 offset:10240
    ds_read_b64_tr_b16 v[90:91], v118 offset:11520
    ds_read_b64_tr_b16 v[92:93], v119 offset:10240
    ds_read_b64_tr_b16 v[94:95], v119 offset:11520
    ds_read_b64_tr_b16 v[96:97], v120 offset:10240
    ds_read_b64_tr_b16 v[98:99], v120 offset:11520
    ds_read_b64_tr_b16 v[100:101], v121 offset:10240
    ds_read_b64_tr_b16 v[102:103], v121 offset:11520
    s_waitcnt lgkmcnt(12)
    v_mfma_f32_16x16x32_bf16 v[8:11], v[56:59], v[48:51], v[8:11]
    v_mfma_f32_16x16x32_bf16 v[12:15], v[60:63], v[48:51], v[12:15]
    v_mfma_f32_16x16x32_bf16 v[16:19], v[64:67], v[48:51], v[16:19]
    v_mfma_f32_16x16x32_bf16 v[20:23], v[68:71], v[48:51], v[20:23]
    v_mfma_f32_16x16x32_bf16 v[24:27], v[72:75], v[48:51], v[24:27]
    v_mfma_f32_16x16x32_bf16 v[28:31], v[56:59], v[52:55], v[28:31]
    v_mfma_f32_16x16x32_bf16 v[32:35], v[60:63], v[52:55], v[32:35]
    v_mfma_f32_16x16x32_bf16 v[36:39], v[64:67], v[52:55], v[36:39]
    v_mfma_f32_16x16x32_bf16 v[40:43], v[68:71], v[52:55], v[40:43]
    v_mfma_f32_16x16x32_bf16 v[44:47], v[72:75], v[52:55], v[44:47]
    v_add_u32 v113, s30, v104
    v_add_u32 v114, s30, v106
    v_add_u32 v117, s30, v108
    v_add_u32 v118, s30, v109
    v_add_u32 v119, s30, v110
    v_add_u32 v120, s30, v111
    v_add_u32 v121, s30, v112
    ds_read_b128 v[48:51], v113
    ds_read_b128 v[52:55], v114
    ds_read_b64_tr_b16 v[56:57], v117 offset:0
    ds_read_b64_tr_b16 v[58:59], v117 offset:1280
    ds_read_b64_tr_b16 v[60:61], v118 offset:0
    ds_read_b64_tr_b16 v[62:63], v118 offset:1280
    ds_read_b64_tr_b16 v[64:65], v119 offset:0
    ds_read_b64_tr_b16 v[66:67], v119 offset:1280
    ds_read_b64_tr_b16 v[68:69], v120 offset:0
    ds_read_b64_tr_b16 v[70:71], v120 offset:1280
    ds_read_b64_tr_b16 v[72:73], v121 offset:0
    ds_read_b64_tr_b16 v[74:75], v121 offset:1280
    s_waitcnt lgkmcnt(12)
    v_mfma_f32_16x16x32_bf16 v[8:11], v[84:87], v[76:79], v[8:11]
    v_mfma_f32_16x16x32_bf16 v[12:15], v[88:91], v[76:79], v[12:15]
    v_mfma_f32_16x16x32_bf16 v[16:19], v[92:95], v[76:79], v[16:19]
    v_mfma_f32_16x16x32_bf16 v[20:23], v[96:99], v[76:79], v[20:23]
    v_mfma_f32_16x16x32_bf16 v[24:27], v[100:103], v[76:79], v[24:27]
    v_mfma_f32_16x16x32_bf16 v[28:31], v[84:87], v[80:83], v[28:31]
    v_mfma_f32_16x16x32_bf16 v[32:35], v[88:91], v[80:83], v[32:35]
    v_mfma_f32_16x16x32_bf16 v[36:39], v[92:95], v[80:83], v[36:39]
    v_mfma_f32_16x16x32_bf16 v[40:43], v[96:99], v[80:83], v[40:43]
    v_mfma_f32_16x16x32_bf16 v[44:47], v[100:103], v[80:83], v[44:47]
    s_mov_b32 s29, s30
    s_add_u32 s30, s30, 36864
    s_cmp_eq_u32 s30, 147456
    s_cselect_b32 s30, 0, s30
    s_add_u32 s28, s28, 36864
    s_cmp_eq_u32 s28, 147456
    s_cselect_b32 s28, 0, s28
    s_add_u32 s21, s21, 128
    s_add_u32 s22, s22, 245760

    v_add_u32 v113, s29, v105
    v_add_u32 v114, s29, v107
    v_add_u32 v117, s29, v108
    v_add_u32 v118, s29, v109
    v_add_u32 v119, s29, v110
    v_add_u32 v120, s29, v111
    v_add_u32 v121, s29, v112
    ds_read_b128 v[76:79], v113
    ds_read_b128 v[80:83], v114
    ds_read_b64_tr_b16 v[84:85], v117 offset:10240
    ds_read_b64_tr_b16 v[86:87], v117 offset:11520
    ds_read_b64_tr_b16 v[88:89], v118 offset:10240
    ds_read_b64_tr_b16 v[90:91], v118 offset:11520
    ds_read_b64_tr_b16 v[92:93], v119 offset:10240
    ds_read_b64_tr_b16 v[94:95], v119 offset:11520
    ds_read_b64_tr_b16 v[96:97], v120 offset:10240
    ds_read_b64_tr_b16 v[98:99], v120 offset:11520
    ds_read_b64_tr_b16 v[100:101], v121 offset:10240
    ds_read_b64_tr_b16 v[102:103], v121 offset:11520
    s_waitcnt lgkmcnt(12)
    v_mfma_f32_16x16x32_bf16 v[8:11], v[56:59], v[48:51], v[8:11]
    v_mfma_f32_16x16x32_bf16 v[12:15], v[60:63], v[48:51], v[12:15]
    v_mfma_f32_16x16x32_bf16 v[16:19], v[64:67], v[48:51], v[16:19]
    v_mfma_f32_16x16x32_bf16 v[20:23], v[68:71], v[48:51], v[20:23]
    v_mfma_f32_16x16x32_bf16 v[24:27], v[72:75], v[48:51], v[24:27]
    v_mfma_f32_16x16x32_bf16 v[28:31], v[56:59], v[52:55], v[28:31]
    v_mfma_f32_16x16x32_bf16 v[32:35], v[60:63], v[52:55], v[32:35]
    v_mfma_f32_16x16x32_bf16 v[36:39], v[64:67], v[52:55], v[36:39]
    v_mfma_f32_16x16x32_bf16 v[40:43], v[68:71], v[52:55], v[40:43]
    v_mfma_f32_16x16x32_bf16 v[44:47], v[72:75], v[52:55], v[44:47]
    s_waitcnt lgkmcnt(0)
    v_mfma_f32_16x16x32_bf16 v[8:11], v[84:87], v[76:79], v[8:11]
    v_mfma_f32_16x16x32_bf16 v[12:15], v[88:91], v[76:79], v[12:15]
    v_mfma_f32_16x16x32_bf16 v[16:19], v[92:95], v[76:79], v[16:19]
    v_mfma_f32_16x16x32_bf16 v[20:23], v[96:99], v[76:79], v[20:23]
    v_mfma_f32_16x16x32_bf16 v[24:27], v[100:103], v[76:79], v[24:27]
    v_mfma_f32_16x16x32_bf16 v[28:31], v[84:87], v[80:83], v[28:31]
    v_mfma_f32_16x16x32_bf16 v[32:35], v[88:91], v[80:83], v[32:35]
    v_mfma_f32_16x16x32_bf16 v[36:39], v[92:95], v[80:83], v[36:39]
    v_mfma_f32_16x16x32_bf16 v[40:43], v[96:99], v[80:83], v[40:43]
    v_mfma_f32_16x16x32_bf16 v[44:47], v[100:103], v[80:83], v[44:47]
    s_nop 15
    s_nop 7
    s_cmp_ge_u32 s17, 4
    s_cbranch_scc1 Lqkv_noscale
    s_mov_b32 s20, 0x3ea52b5c
    v_mul_f32 v8, s20, v8
    v_mul_f32 v9, s20, v9
    v_mul_f32 v10, s20, v10
    v_mul_f32 v11, s20, v11
    v_mul_f32 v12, s20, v12
    v_mul_f32 v13, s20, v13
    v_mul_f32 v14, s20, v14
    v_mul_f32 v15, s20, v15
    v_mul_f32 v16, s20, v16
    v_mul_f32 v17, s20, v17
    v_mul_f32 v18, s20, v18
    v_mul_f32 v19, s20, v19
    v_mul_f32 v20, s20, v20
    v_mul_f32 v21, s20, v21
    v_mul_f32 v22, s20, v22
    v_mul_f32 v23, s20, v23
    v_mul_f32 v24, s20, v24
    v_mul_f32 v25, s20, v25
    v_mul_f32 v26, s20, v26
    v_mul_f32 v27, s20, v27
    v_mul_f32 v28, s20, v28
    v_mul_f32 v29, s20, v29
    v_mul_f32 v30, s20, v30
    v_mul_f32 v31, s20, v31
    v_mul_f32 v32, s20, v32
    v_mul_f32 v33, s20, v33
    v_mul_f32 v34, s20, v34
    v_mul_f32 v35, s20, v35
    v_mul_f32 v36, s20, v36
    v_mul_f32 v37, s20, v37
    v_mul_f32 v38, s20, v38
    v_mul_f32 v39, s20, v39
    v_mul_f32 v40, s20, v40
    v_mul_f32 v41, s20, v41
    v_mul_f32 v42, s20, v42
    v_mul_f32 v43, s20, v43
    v_mul_f32 v44, s20, v44
    v_mul_f32 v45, s20, v45
    v_mul_f32 v46, s20, v46
    v_mul_f32 v47, s20, v47
Lqkv_noscale:
    s_lshr_b32 s20, s17, 2
    s_mul_i32 s20, s20, 2621440
    s_and_b32 s21, s17, 3
    s_lshl_b32 s21, s21, 3
    s_lshl_b32 s22, s24, 2
    s_add_u32 s21, s21, s22
    s_mul_i32 s21, s21, 81920
    s_add_u32 s20, s20, s21
    s_lshl_b32 s21, s16, 2
    s_add_u32 s21, s21, s19
    s_mul_i32 s21, s21, 1280
    s_add_u32 s20, s20, s21
    v_mov_b32 v136, 256
    v_mov_b32 v137, 128
    v_lshlrev_b32 v138, 4, v3
    v_lshlrev_b32 v139, 3, v3
    v_add_u32 v139, 1024, v139

    v_add_u32 v128, 0, v2
    v_mul_u32_u24 v129, 52, v128
    v_lshrrev_b32 v129, 8, v129
    v_mul_u32_u24 v130, 5, v129
    v_sub_u32 v130, v128, v130
    v_lshrrev_b32 v131, 1, v130
    v_lshl_add_u32 v131, v131, 9, v138
    v_and_b32 v132, 1, v130
    v_lshl_add_u32 v131, v132, 3, v131
    v_cmp_eq_u32 vcc, 4, v130
    v_mul_u32_u24 v129, 81920, v129
    s_nop 1
    v_cndmask_b32 v131, v131, v139, vcc
    v_add_u32 v131, v131, v129
    v_cndmask_b32 v132, v136, v137, vcc
    v_add_u32 v132, v132, v131

    v_cvt_pk_bf16_f32 v134, v8, v9
    v_cvt_pk_bf16_f32 v135, v10, v11
    buffer_store_dwordx2 v[134:135], v131, s[12:15], s20 offen
    s_nop 1
    v_cvt_pk_bf16_f32 v134, v28, v29
    v_cvt_pk_bf16_f32 v135, v30, v31
    buffer_store_dwordx2 v[134:135], v132, s[12:15], s20 offen
    s_nop 1
    v_add_u32 v128, 4, v2
    v_mul_u32_u24 v129, 52, v128
    v_lshrrev_b32 v129, 8, v129
    v_mul_u32_u24 v130, 5, v129
    v_sub_u32 v130, v128, v130
    v_lshrrev_b32 v131, 1, v130
    v_lshl_add_u32 v131, v131, 9, v138
    v_and_b32 v132, 1, v130
    v_lshl_add_u32 v131, v132, 3, v131
    v_cmp_eq_u32 vcc, 4, v130
    v_mul_u32_u24 v129, 81920, v129
    s_nop 1
    v_cndmask_b32 v131, v131, v139, vcc
    v_add_u32 v131, v131, v129
    v_cndmask_b32 v132, v136, v137, vcc
    v_add_u32 v132, v132, v131

    v_cvt_pk_bf16_f32 v134, v12, v13
    v_cvt_pk_bf16_f32 v135, v14, v15
    buffer_store_dwordx2 v[134:135], v131, s[12:15], s20 offen
    s_nop 1
    v_cvt_pk_bf16_f32 v134, v32, v33
    v_cvt_pk_bf16_f32 v135, v34, v35
    buffer_store_dwordx2 v[134:135], v132, s[12:15], s20 offen
    s_nop 1
    v_add_u32 v128, 8, v2
    v_mul_u32_u24 v129, 52, v128
    v_lshrrev_b32 v129, 8, v129
    v_mul_u32_u24 v130, 5, v129
    v_sub_u32 v130, v128, v130
    v_lshrrev_b32 v131, 1, v130
    v_lshl_add_u32 v131, v131, 9, v138
    v_and_b32 v132, 1, v130
    v_lshl_add_u32 v131, v132, 3, v131
    v_cmp_eq_u32 vcc, 4, v130
    v_mul_u32_u24 v129, 81920, v129
    s_nop 1
    v_cndmask_b32 v131, v131, v139, vcc
    v_add_u32 v131, v131, v129
    v_cndmask_b32 v132, v136, v137, vcc
    v_add_u32 v132, v132, v131

    v_cvt_pk_bf16_f32 v134, v16, v17
    v_cvt_pk_bf16_f32 v135, v18, v19
    buffer_store_dwordx2 v[134:135], v131, s[12:15], s20 offen
    s_nop 1
    v_cvt_pk_bf16_f32 v134, v36, v37
    v_cvt_pk_bf16_f32 v135, v38, v39
    buffer_store_dwordx2 v[134:135], v132, s[12:15], s20 offen
    s_nop 1
    v_add_u32 v128, 12, v2
    v_mul_u32_u24 v129, 52, v128
    v_lshrrev_b32 v129, 8, v129
    v_mul_u32_u24 v130, 5, v129
    v_sub_u32 v130, v128, v130
    v_lshrrev_b32 v131, 1, v130
    v_lshl_add_u32 v131, v131, 9, v138
    v_and_b32 v132, 1, v130
    v_lshl_add_u32 v131, v132, 3, v131
    v_cmp_eq_u32 vcc, 4, v130
    v_mul_u32_u24 v129, 81920, v129
    s_nop 1
    v_cndmask_b32 v131, v131, v139, vcc
    v_add_u32 v131, v131, v129
    v_cndmask_b32 v132, v136, v137, vcc
    v_add_u32 v132, v132, v131

    v_cvt_pk_bf16_f32 v134, v20, v21
    v_cvt_pk_bf16_f32 v135, v22, v23
    buffer_store_dwordx2 v[134:135], v131, s[12:15], s20 offen
    s_nop 1
    v_cvt_pk_bf16_f32 v134, v40, v41
    v_cvt_pk_bf16_f32 v135, v42, v43
    buffer_store_dwordx2 v[134:135], v132, s[12:15], s20 offen
    s_nop 1
    v_add_u32 v128, 16, v2
    v_mul_u32_u24 v129, 52, v128
    v_lshrrev_b32 v129, 8, v129
    v_mul_u32_u24 v130, 5, v129
    v_sub_u32 v130, v128, v130
    v_lshrrev_b32 v131, 1, v130
    v_lshl_add_u32 v131, v131, 9, v138
    v_and_b32 v132, 1, v130
    v_lshl_add_u32 v131, v132, 3, v131
    v_cmp_eq_u32 vcc, 4, v130
    v_mul_u32_u24 v129, 81920, v129
    s_nop 1
    v_cndmask_b32 v131, v131, v139, vcc
    v_add_u32 v131, v131, v129
    v_cndmask_b32 v132, v136, v137, vcc
    v_add_u32 v132, v132, v131

    v_cvt_pk_bf16_f32 v134, v24, v25
    v_cvt_pk_bf16_f32 v135, v26, v27
    buffer_store_dwordx2 v[134:135], v131, s[12:15], s20 offen
    s_nop 1
    v_cvt_pk_bf16_f32 v134, v44, v45
    v_cvt_pk_bf16_f32 v135, v46, v47
    buffer_store_dwordx2 v[134:135], v132, s[12:15], s20 offen
    s_nop 1
    s_branch Lqkv_fin
Lqkv_vtype:
    s_mov_b32 s29, 0
    s_mov_b32 s30, 36864
    s_mov_b32 s28, 110592
    s_mov_b32 s31, 0
    s_waitcnt vmcnt(10)
    s_barrier

    v_add_u32 v113, s29, v104
    v_add_u32 v114, s29, v106
    v_add_u32 v117, s29, v108
    v_add_u32 v118, s29, v109
    v_add_u32 v119, s29, v110
    v_add_u32 v120, s29, v111
    v_add_u32 v121, s29, v112
    ds_read_b128 v[48:51], v113
    ds_read_b128 v[52:55], v114
    ds_read_b64_tr_b16 v[56:57], v117 offset:0
    ds_read_b64_tr_b16 v[58:59], v117 offset:1280
    ds_read_b64_tr_b16 v[60:61], v118 offset:0
    ds_read_b64_tr_b16 v[62:63], v118 offset:1280
    ds_read_b64_tr_b16 v[64:65], v119 offset:0
    ds_read_b64_tr_b16 v[66:67], v119 offset:1280
    ds_read_b64_tr_b16 v[68:69], v120 offset:0
    ds_read_b64_tr_b16 v[70:71], v120 offset:1280
    ds_read_b64_tr_b16 v[72:73], v121 offset:0
    ds_read_b64_tr_b16 v[74:75], v121 offset:1280
Lqkv_loopb:
    s_waitcnt vmcnt(5)
    s_barrier
    s_add_u32 s20, s28, s27
    s_add_u32 m0, s20, 0
    buffer_load_dwordx4 v122, s[4:7], s21 offen lds

    s_add_u32 s20, s28, s27
    s_add_u32 m0, s20, 8192
    buffer_load_dwordx4 v123, s[4:7], s21 offen lds

    s_add_u32 s20, s28, s27
    s_add_u32 m0, s20, 16384
    buffer_load_dwordx4 v124, s[8:11], s22 offen lds

    s_add_u32 s20, s28, s27
    s_add_u32 m0, s20, 24576
    buffer_load_dwordx4 v125, s[8:11], s22 offen lds

    s_add_u32 s20, s28, s27
    s_add_u32 s20, s20, 32768
    s_and_b32 s20, s20, s25
    s_add_u32 m0, s20, s26
    buffer_load_dwordx4 v126, s[8:11], s22 offen lds

    v_add_u32 v113, s29, v105
    v_add_u32 v114, s29, v107
    v_add_u32 v117, s29, v108
    v_add_u32 v118, s29, v109
    v_add_u32 v119, s29, v110
    v_add_u32 v120, s29, v111
    v_add_u32 v121, s29, v112
    ds_read_b128 v[76:79], v113
    ds_read_b128 v[80:83], v114
    ds_read_b64_tr_b16 v[84:85], v117 offset:10240
    ds_read_b64_tr_b16 v[86:87], v117 offset:11520
    ds_read_b64_tr_b16 v[88:89], v118 offset:10240
    ds_read_b64_tr_b16 v[90:91], v118 offset:11520
    ds_read_b64_tr_b16 v[92:93], v119 offset:10240
    ds_read_b64_tr_b16 v[94:95], v119 offset:11520
    ds_read_b64_tr_b16 v[96:97], v120 offset:10240
    ds_read_b64_tr_b16 v[98:99], v120 offset:11520
    ds_read_b64_tr_b16 v[100:101], v121 offset:10240
    ds_read_b64_tr_b16 v[102:103], v121 offset:11520
    s_waitcnt lgkmcnt(12)
    v_mfma_f32_16x16x32_bf16 v[8:11], v[48:51], v[56:59], v[8:11]
    v_mfma_f32_16x16x32_bf16 v[12:15], v[48:51], v[60:63], v[12:15]
    v_mfma_f32_16x16x32_bf16 v[16:19], v[48:51], v[64:67], v[16:19]
    v_mfma_f32_16x16x32_bf16 v[20:23], v[48:51], v[68:71], v[20:23]
    v_mfma_f32_16x16x32_bf16 v[24:27], v[48:51], v[72:75], v[24:27]
    v_mfma_f32_16x16x32_bf16 v[28:31], v[52:55], v[56:59], v[28:31]
    v_mfma_f32_16x16x32_bf16 v[32:35], v[52:55], v[60:63], v[32:35]
    v_mfma_f32_16x16x32_bf16 v[36:39], v[52:55], v[64:67], v[36:39]
    v_mfma_f32_16x16x32_bf16 v[40:43], v[52:55], v[68:71], v[40:43]
    v_mfma_f32_16x16x32_bf16 v[44:47], v[52:55], v[72:75], v[44:47]
    v_add_u32 v113, s30, v104
    v_add_u32 v114, s30, v106
    v_add_u32 v117, s30, v108
    v_add_u32 v118, s30, v109
    v_add_u32 v119, s30, v110
    v_add_u32 v120, s30, v111
    v_add_u32 v121, s30, v112
    ds_read_b128 v[48:51], v113
    ds_read_b128 v[52:55], v114
    ds_read_b64_tr_b16 v[56:57], v117 offset:0
    ds_read_b64_tr_b16 v[58:59], v117 offset:1280
    ds_read_b64_tr_b16 v[60:61], v118 offset:0
    ds_read_b64_tr_b16 v[62:63], v118 offset:1280
    ds_read_b64_tr_b16 v[64:65], v119 offset:0
    ds_read_b64_tr_b16 v[66:67], v119 offset:1280
    ds_read_b64_tr_b16 v[68:69], v120 offset:0
    ds_read_b64_tr_b16 v[70:71], v120 offset:1280
    ds_read_b64_tr_b16 v[72:73], v121 offset:0
    ds_read_b64_tr_b16 v[74:75], v121 offset:1280
    s_waitcnt lgkmcnt(12)
    v_mfma_f32_16x16x32_bf16 v[8:11], v[76:79], v[84:87], v[8:11]
    v_mfma_f32_16x16x32_bf16 v[12:15], v[76:79], v[88:91], v[12:15]
    v_mfma_f32_16x16x32_bf16 v[16:19], v[76:79], v[92:95], v[16:19]
    v_mfma_f32_16x16x32_bf16 v[20:23], v[76:79], v[96:99], v[20:23]
    v_mfma_f32_16x16x32_bf16 v[24:27], v[76:79], v[100:103], v[24:27]
    v_mfma_f32_16x16x32_bf16 v[28:31], v[80:83], v[84:87], v[28:31]
    v_mfma_f32_16x16x32_bf16 v[32:35], v[80:83], v[88:91], v[32:35]
    v_mfma_f32_16x16x32_bf16 v[36:39], v[80:83], v[92:95], v[36:39]
    v_mfma_f32_16x16x32_bf16 v[40:43], v[80:83], v[96:99], v[40:43]
    v_mfma_f32_16x16x32_bf16 v[44:47], v[80:83], v[100:103], v[44:47]
    s_mov_b32 s29, s30
    s_add_u32 s30, s30, 36864
    s_cmp_eq_u32 s30, 147456
    s_cselect_b32 s30, 0, s30
    s_add_u32 s28, s28, 36864
    s_cmp_eq_u32 s28, 147456
    s_cselect_b32 s28, 0, s28
    s_add_u32 s21, s21, 128
    s_add_u32 s22, s22, 245760

    s_add_u32 s31, s31, 1
    s_cmp_lt_u32 s31, 7
    s_cbranch_scc1 Lqkv_loopb

    s_waitcnt vmcnt(5)
    s_barrier
    v_add_u32 v113, s29, v105
    v_add_u32 v114, s29, v107
    v_add_u32 v117, s29, v108
    v_add_u32 v118, s29, v109
    v_add_u32 v119, s29, v110
    v_add_u32 v120, s29, v111
    v_add_u32 v121, s29, v112
    ds_read_b128 v[76:79], v113
    ds_read_b128 v[80:83], v114
    ds_read_b64_tr_b16 v[84:85], v117 offset:10240
    ds_read_b64_tr_b16 v[86:87], v117 offset:11520
    ds_read_b64_tr_b16 v[88:89], v118 offset:10240
    ds_read_b64_tr_b16 v[90:91], v118 offset:11520
    ds_read_b64_tr_b16 v[92:93], v119 offset:10240
    ds_read_b64_tr_b16 v[94:95], v119 offset:11520
    ds_read_b64_tr_b16 v[96:97], v120 offset:10240
    ds_read_b64_tr_b16 v[98:99], v120 offset:11520
    ds_read_b64_tr_b16 v[100:101], v121 offset:10240
    ds_read_b64_tr_b16 v[102:103], v121 offset:11520
    s_waitcnt lgkmcnt(12)
    v_mfma_f32_16x16x32_bf16 v[8:11], v[48:51], v[56:59], v[8:11]
    v_mfma_f32_16x16x32_bf16 v[12:15], v[48:51], v[60:63], v[12:15]
    v_mfma_f32_16x16x32_bf16 v[16:19], v[48:51], v[64:67], v[16:19]
    v_mfma_f32_16x16x32_bf16 v[20:23], v[48:51], v[68:71], v[20:23]
    v_mfma_f32_16x16x32_bf16 v[24:27], v[48:51], v[72:75], v[24:27]
    v_mfma_f32_16x16x32_bf16 v[28:31], v[52:55], v[56:59], v[28:31]
    v_mfma_f32_16x16x32_bf16 v[32:35], v[52:55], v[60:63], v[32:35]
    v_mfma_f32_16x16x32_bf16 v[36:39], v[52:55], v[64:67], v[36:39]
    v_mfma_f32_16x16x32_bf16 v[40:43], v[52:55], v[68:71], v[40:43]
    v_mfma_f32_16x16x32_bf16 v[44:47], v[52:55], v[72:75], v[44:47]
    v_add_u32 v113, s30, v104
    v_add_u32 v114, s30, v106
    v_add_u32 v117, s30, v108
    v_add_u32 v118, s30, v109
    v_add_u32 v119, s30, v110
    v_add_u32 v120, s30, v111
    v_add_u32 v121, s30, v112
    ds_read_b128 v[48:51], v113
    ds_read_b128 v[52:55], v114
    ds_read_b64_tr_b16 v[56:57], v117 offset:0
    ds_read_b64_tr_b16 v[58:59], v117 offset:1280
    ds_read_b64_tr_b16 v[60:61], v118 offset:0
    ds_read_b64_tr_b16 v[62:63], v118 offset:1280
    ds_read_b64_tr_b16 v[64:65], v119 offset:0
    ds_read_b64_tr_b16 v[66:67], v119 offset:1280
    ds_read_b64_tr_b16 v[68:69], v120 offset:0
    ds_read_b64_tr_b16 v[70:71], v120 offset:1280
    ds_read_b64_tr_b16 v[72:73], v121 offset:0
    ds_read_b64_tr_b16 v[74:75], v121 offset:1280
    s_waitcnt lgkmcnt(12)
    v_mfma_f32_16x16x32_bf16 v[8:11], v[76:79], v[84:87], v[8:11]
    v_mfma_f32_16x16x32_bf16 v[12:15], v[76:79], v[88:91], v[12:15]
    v_mfma_f32_16x16x32_bf16 v[16:19], v[76:79], v[92:95], v[16:19]
    v_mfma_f32_16x16x32_bf16 v[20:23], v[76:79], v[96:99], v[20:23]
    v_mfma_f32_16x16x32_bf16 v[24:27], v[76:79], v[100:103], v[24:27]
    v_mfma_f32_16x16x32_bf16 v[28:31], v[80:83], v[84:87], v[28:31]
    v_mfma_f32_16x16x32_bf16 v[32:35], v[80:83], v[88:91], v[32:35]
    v_mfma_f32_16x16x32_bf16 v[36:39], v[80:83], v[92:95], v[36:39]
    v_mfma_f32_16x16x32_bf16 v[40:43], v[80:83], v[96:99], v[40:43]
    v_mfma_f32_16x16x32_bf16 v[44:47], v[80:83], v[100:103], v[44:47]
    s_mov_b32 s29, s30
    s_add_u32 s30, s30, 36864
    s_cmp_eq_u32 s30, 147456
    s_cselect_b32 s30, 0, s30
    s_add_u32 s28, s28, 36864
    s_cmp_eq_u32 s28, 147456
    s_cselect_b32 s28, 0, s28
    s_add_u32 s21, s21, 128
    s_add_u32 s22, s22, 245760

    s_waitcnt vmcnt(0)
    s_barrier
    v_add_u32 v113, s29, v105
    v_add_u32 v114, s29, v107
    v_add_u32 v117, s29, v108
    v_add_u32 v118, s29, v109
    v_add_u32 v119, s29, v110
    v_add_u32 v120, s29, v111
    v_add_u32 v121, s29, v112
    ds_read_b128 v[76:79], v113
    ds_read_b128 v[80:83], v114
    ds_read_b64_tr_b16 v[84:85], v117 offset:10240
    ds_read_b64_tr_b16 v[86:87], v117 offset:11520
    ds_read_b64_tr_b16 v[88:89], v118 offset:10240
    ds_read_b64_tr_b16 v[90:91], v118 offset:11520
    ds_read_b64_tr_b16 v[92:93], v119 offset:10240
    ds_read_b64_tr_b16 v[94:95], v119 offset:11520
    ds_read_b64_tr_b16 v[96:97], v120 offset:10240
    ds_read_b64_tr_b16 v[98:99], v120 offset:11520
    ds_read_b64_tr_b16 v[100:101], v121 offset:10240
    ds_read_b64_tr_b16 v[102:103], v121 offset:11520
    s_waitcnt lgkmcnt(12)
    v_mfma_f32_16x16x32_bf16 v[8:11], v[48:51], v[56:59], v[8:11]
    v_mfma_f32_16x16x32_bf16 v[12:15], v[48:51], v[60:63], v[12:15]
    v_mfma_f32_16x16x32_bf16 v[16:19], v[48:51], v[64:67], v[16:19]
    v_mfma_f32_16x16x32_bf16 v[20:23], v[48:51], v[68:71], v[20:23]
    v_mfma_f32_16x16x32_bf16 v[24:27], v[48:51], v[72:75], v[24:27]
    v_mfma_f32_16x16x32_bf16 v[28:31], v[52:55], v[56:59], v[28:31]
    v_mfma_f32_16x16x32_bf16 v[32:35], v[52:55], v[60:63], v[32:35]
    v_mfma_f32_16x16x32_bf16 v[36:39], v[52:55], v[64:67], v[36:39]
    v_mfma_f32_16x16x32_bf16 v[40:43], v[52:55], v[68:71], v[40:43]
    v_mfma_f32_16x16x32_bf16 v[44:47], v[52:55], v[72:75], v[44:47]
    v_add_u32 v113, s30, v104
    v_add_u32 v114, s30, v106
    v_add_u32 v117, s30, v108
    v_add_u32 v118, s30, v109
    v_add_u32 v119, s30, v110
    v_add_u32 v120, s30, v111
    v_add_u32 v121, s30, v112
    ds_read_b128 v[48:51], v113
    ds_read_b128 v[52:55], v114
    ds_read_b64_tr_b16 v[56:57], v117 offset:0
    ds_read_b64_tr_b16 v[58:59], v117 offset:1280
    ds_read_b64_tr_b16 v[60:61], v118 offset:0
    ds_read_b64_tr_b16 v[62:63], v118 offset:1280
    ds_read_b64_tr_b16 v[64:65], v119 offset:0
    ds_read_b64_tr_b16 v[66:67], v119 offset:1280
    ds_read_b64_tr_b16 v[68:69], v120 offset:0
    ds_read_b64_tr_b16 v[70:71], v120 offset:1280
    ds_read_b64_tr_b16 v[72:73], v121 offset:0
    ds_read_b64_tr_b16 v[74:75], v121 offset:1280
    s_waitcnt lgkmcnt(12)
    v_mfma_f32_16x16x32_bf16 v[8:11], v[76:79], v[84:87], v[8:11]
    v_mfma_f32_16x16x32_bf16 v[12:15], v[76:79], v[88:91], v[12:15]
    v_mfma_f32_16x16x32_bf16 v[16:19], v[76:79], v[92:95], v[16:19]
    v_mfma_f32_16x16x32_bf16 v[20:23], v[76:79], v[96:99], v[20:23]
    v_mfma_f32_16x16x32_bf16 v[24:27], v[76:79], v[100:103], v[24:27]
    v_mfma_f32_16x16x32_bf16 v[28:31], v[80:83], v[84:87], v[28:31]
    v_mfma_f32_16x16x32_bf16 v[32:35], v[80:83], v[88:91], v[32:35]
    v_mfma_f32_16x16x32_bf16 v[36:39], v[80:83], v[92:95], v[36:39]
    v_mfma_f32_16x16x32_bf16 v[40:43], v[80:83], v[96:99], v[40:43]
    v_mfma_f32_16x16x32_bf16 v[44:47], v[80:83], v[100:103], v[44:47]
    s_mov_b32 s29, s30
    s_add_u32 s30, s30, 36864
    s_cmp_eq_u32 s30, 147456
    s_cselect_b32 s30, 0, s30
    s_add_u32 s28, s28, 36864
    s_cmp_eq_u32 s28, 147456
    s_cselect_b32 s28, 0, s28
    s_add_u32 s21, s21, 128
    s_add_u32 s22, s22, 245760

    v_add_u32 v113, s29, v105
    v_add_u32 v114, s29, v107
    v_add_u32 v117, s29, v108
    v_add_u32 v118, s29, v109
    v_add_u32 v119, s29, v110
    v_add_u32 v120, s29, v111
    v_add_u32 v121, s29, v112
    ds_read_b128 v[76:79], v113
    ds_read_b128 v[80:83], v114
    ds_read_b64_tr_b16 v[84:85], v117 offset:10240
    ds_read_b64_tr_b16 v[86:87], v117 offset:11520
    ds_read_b64_tr_b16 v[88:89], v118 offset:10240
    ds_read_b64_tr_b16 v[90:91], v118 offset:11520
    ds_read_b64_tr_b16 v[92:93], v119 offset:10240
    ds_read_b64_tr_b16 v[94:95], v119 offset:11520
    ds_read_b64_tr_b16 v[96:97], v120 offset:10240
    ds_read_b64_tr_b16 v[98:99], v120 offset:11520
    ds_read_b64_tr_b16 v[100:101], v121 offset:10240
    ds_read_b64_tr_b16 v[102:103], v121 offset:11520
    s_waitcnt lgkmcnt(12)
    v_mfma_f32_16x16x32_bf16 v[8:11], v[48:51], v[56:59], v[8:11]
    v_mfma_f32_16x16x32_bf16 v[12:15], v[48:51], v[60:63], v[12:15]
    v_mfma_f32_16x16x32_bf16 v[16:19], v[48:51], v[64:67], v[16:19]
    v_mfma_f32_16x16x32_bf16 v[20:23], v[48:51], v[68:71], v[20:23]
    v_mfma_f32_16x16x32_bf16 v[24:27], v[48:51], v[72:75], v[24:27]
    v_mfma_f32_16x16x32_bf16 v[28:31], v[52:55], v[56:59], v[28:31]
    v_mfma_f32_16x16x32_bf16 v[32:35], v[52:55], v[60:63], v[32:35]
    v_mfma_f32_16x16x32_bf16 v[36:39], v[52:55], v[64:67], v[36:39]
    v_mfma_f32_16x16x32_bf16 v[40:43], v[52:55], v[68:71], v[40:43]
    v_mfma_f32_16x16x32_bf16 v[44:47], v[52:55], v[72:75], v[44:47]
    s_waitcnt lgkmcnt(0)
    v_mfma_f32_16x16x32_bf16 v[8:11], v[76:79], v[84:87], v[8:11]
    v_mfma_f32_16x16x32_bf16 v[12:15], v[76:79], v[88:91], v[12:15]
    v_mfma_f32_16x16x32_bf16 v[16:19], v[76:79], v[92:95], v[16:19]
    v_mfma_f32_16x16x32_bf16 v[20:23], v[76:79], v[96:99], v[20:23]
    v_mfma_f32_16x16x32_bf16 v[24:27], v[76:79], v[100:103], v[24:27]
    v_mfma_f32_16x16x32_bf16 v[28:31], v[80:83], v[84:87], v[28:31]
    v_mfma_f32_16x16x32_bf16 v[32:35], v[80:83], v[88:91], v[32:35]
    v_mfma_f32_16x16x32_bf16 v[36:39], v[80:83], v[92:95], v[36:39]
    v_mfma_f32_16x16x32_bf16 v[40:43], v[80:83], v[96:99], v[40:43]
    v_mfma_f32_16x16x32_bf16 v[44:47], v[80:83], v[100:103], v[44:47]
    s_nop 15
    s_nop 7
    s_and_b32 s21, s17, 3
    s_lshl_b32 s21, s21, 3
    s_lshl_b32 s22, s24, 2
    s_add_u32 s21, s21, s22
    s_mul_i32 s21, s21, 86016
    s_add_u32 s20, s21, 5242880
    s_lshl_b32 s21, s16, 2
    s_add_u32 s21, s21, s19
    s_mul_i32 s21, s21, 1344
    s_add_u32 s20, s20, s21
    v_bfe_u32 v136, v1, 4, 1
    v_mul_u32_u24 v136, 336, v136
    v_bfe_u32 v137, v1, 5, 1
    v_lshl_add_u32 v136, v137, 3, v136

    v_add_u32 v128, 0, v3
    v_mul_u32_u24 v129, 205, v128
    v_lshrrev_b32 v129, 12, v129
    v_mul_u32_u24 v130, 20, v129
    v_sub_u32 v130, v128, v130
    v_lshl_add_u32 v130, v130, 4, v136
    v_mul_u32_u24 v129, 86016, v129
    v_add_u32 v130, v130, v129

    v_cvt_pk_bf16_f32 v134, v8, v9
    v_cvt_pk_bf16_f32 v135, v10, v11
    buffer_store_dwordx2 v[134:135], v130, s[12:15], s20 offen offset:0
    s_nop 1
    v_cvt_pk_bf16_f32 v134, v28, v29
    v_cvt_pk_bf16_f32 v135, v30, v31
    buffer_store_dwordx2 v[134:135], v130, s[12:15], s20 offen offset:672
    s_nop 1
    v_add_u32 v128, 16, v3
    v_mul_u32_u24 v129, 205, v128
    v_lshrrev_b32 v129, 12, v129
    v_mul_u32_u24 v130, 20, v129
    v_sub_u32 v130, v128, v130
    v_lshl_add_u32 v130, v130, 4, v136
    v_mul_u32_u24 v129, 86016, v129
    v_add_u32 v130, v130, v129

    v_cvt_pk_bf16_f32 v134, v12, v13
    v_cvt_pk_bf16_f32 v135, v14, v15
    buffer_store_dwordx2 v[134:135], v130, s[12:15], s20 offen offset:0
    s_nop 1
    v_cvt_pk_bf16_f32 v134, v32, v33
    v_cvt_pk_bf16_f32 v135, v34, v35
    buffer_store_dwordx2 v[134:135], v130, s[12:15], s20 offen offset:672
    s_nop 1
    v_add_u32 v128, 32, v3
    v_mul_u32_u24 v129, 205, v128
    v_lshrrev_b32 v129, 12, v129
    v_mul_u32_u24 v130, 20, v129
    v_sub_u32 v130, v128, v130
    v_lshl_add_u32 v130, v130, 4, v136
    v_mul_u32_u24 v129, 86016, v129
    v_add_u32 v130, v130, v129

    v_cvt_pk_bf16_f32 v134, v16, v17
    v_cvt_pk_bf16_f32 v135, v18, v19
    buffer_store_dwordx2 v[134:135], v130, s[12:15], s20 offen offset:0
    s_nop 1
    v_cvt_pk_bf16_f32 v134, v36, v37
    v_cvt_pk_bf16_f32 v135, v38, v39
    buffer_store_dwordx2 v[134:135], v130, s[12:15], s20 offen offset:672
    s_nop 1
    v_add_u32 v128, 48, v3
    v_mul_u32_u24 v129, 205, v128
    v_lshrrev_b32 v129, 12, v129
    v_mul_u32_u24 v130, 20, v129
    v_sub_u32 v130, v128, v130
    v_lshl_add_u32 v130, v130, 4, v136
    v_mul_u32_u24 v129, 86016, v129
    v_add_u32 v130, v130, v129

    v_cvt_pk_bf16_f32 v134, v20, v21
    v_cvt_pk_bf16_f32 v135, v22, v23
    buffer_store_dwordx2 v[134:135], v130, s[12:15], s20 offen offset:0
    s_nop 1
    v_cvt_pk_bf16_f32 v134, v40, v41
    v_cvt_pk_bf16_f32 v135, v42, v43
    buffer_store_dwordx2 v[134:135], v130, s[12:15], s20 offen offset:672
    s_nop 1
    v_add_u32 v128, 64, v3
    v_mul_u32_u24 v129, 205, v128
    v_lshrrev_b32 v129, 12, v129
    v_mul_u32_u24 v130, 20, v129
    v_sub_u32 v130, v128, v130
    v_lshl_add_u32 v130, v130, 4, v136
    v_mul_u32_u24 v129, 86016, v129
    v_add_u32 v130, v130, v129

    v_cvt_pk_bf16_f32 v134, v24, v25
    v_cvt_pk_bf16_f32 v135, v26, v27
    buffer_store_dwordx2 v[134:135], v130, s[12:15], s20 offen offset:0
    s_nop 1
    v_cvt_pk_bf16_f32 v134, v44, v45
    v_cvt_pk_bf16_f32 v135, v46, v47
    buffer_store_dwordx2 v[134:135], v130, s[12:15], s20 offen offset:672
    s_nop 1
    v_lshrrev_b32 v128, 2, v1
    v_mul_u32_u24 v128, 86016, v128
    v_bfe_u32 v129, v1, 1, 1
    v_mul_u32_u24 v129, 672, v129
    v_and_b32 v130, 1, v1
    v_mul_u32_u24 v130, 336, v130
    v_add3_u32 v128, v128, v129, v130
    v_add_u32 v128, 320, v128
    v_mov_b32 v129, 0x80000000
    v_cmp_gt_u32 vcc, 16, v1
    s_nop 1
    v_cndmask_b32 v128, v129, v128, vcc
    v_mov_b32 v136, 0x3f803f80
    v_mov_b32 v137, 0x3f803f80
    v_mov_b32 v138, 0x3f803f80
    v_mov_b32 v139, 0x3f803f80
    s_nop 1
    buffer_store_dwordx4 v[136:139], v128, s[12:15], s20 offen

Lqkv_fin:
Lqkv_end:
    s_endpgm
    .globl attn_kernel
    .p2align 8
    .type attn_kernel,@function
attn_kernel:
    s_cmp_ge_u32 s2, 256
    s_cbranch_scc1 Lattn_end
    s_nop 0
    s_load_dwordx2 s[4:5], s[0:1], 40
    v_and_b32 v153, 63, v0
    v_lshrrev_b32 v1, 6, v0
    s_and_b32 s20, s2, 7
    s_lshr_b32 s21, s2, 3
    s_and_b32 s22, s21, 3
    s_lshl_b32 s20, s20, 2
    s_add_u32 s8, s20, s22
    s_lshr_b32 s9, s21, 2
    v_readfirstlane_b32 s10, v1
    s_waitcnt lgkmcnt(0)
    s_mov_b32 s6, 10616832
    s_mov_b32 s7, 0x00020000
    s_and_b32 s11, s10, 3
    s_lshr_b32 s12, s10, 2
    v_lshrrev_b32 v154, 5, v153

    s_mul_i32 s20, s8, 81920
    s_lshl_b32 s21, s9, 3
    s_lshl_b32 s22, s11, 1
    s_add_u32 s21, s21, s22
    s_mul_i32 s21, s21, 1280
    s_add_u32 s20, s20, s21
    s_add_u32 s20, s20, 0
    v_lshlrev_b32 v147, 4, v153
    v_and_b32 v148, 31, v153
    v_lshlrev_b32 v148, 3, v148
    v_add_u32 v148, 1024, v148
    v_mov_b32 v149, 0x80000000
    v_cmp_gt_u32 vcc, 32, v153
    s_nop 1
    v_cndmask_b32 v149, v149, v148, vcc
    buffer_load_dwordx4 v[8:11], v147, s[4:7], s20 offen
    buffer_load_dwordx2 v[12:13], v149, s[4:7], s20 offen
    buffer_load_dwordx4 v[16:19], v147, s[4:7], s20 offen offset:1280
    buffer_load_dwordx2 v[20:21], v149, s[4:7], s20 offen offset:1280

    s_mul_i32 s20, s12, 40960
    s_lshl_b32 s21, s11, 10
    s_add_u32 s14, s20, s21
    s_mul_i32 s13, s8, 81920
    s_add_u32 s13, s13, 2621440
    s_add_u32 s13, s13, s14

    s_mov_b32 m0, s14
    s_add_u32 s14, s14, 4096
    buffer_load_dwordx4 v147, s[4:7], s13 offen lds
    s_add_u32 s13, s13, 4096

    s_mov_b32 m0, s14
    s_add_u32 s14, s14, 4096
    buffer_load_dwordx4 v147, s[4:7], s13 offen lds
    s_add_u32 s13, s13, 4096

    s_mov_b32 m0, s14
    s_add_u32 s14, s14, 4096
    buffer_load_dwordx4 v147, s[4:7], s13 offen lds
    s_add_u32 s13, s13, 4096

    s_mov_b32 m0, s14
    s_add_u32 s14, s14, 4096
    buffer_load_dwordx4 v147, s[4:7], s13 offen lds
    s_add_u32 s13, s13, 4096

    s_mov_b32 m0, s14
    s_add_u32 s14, s14, 4096
    buffer_load_dwordx4 v147, s[4:7], s13 offen lds
    s_add_u32 s13, s13, 4096

    s_mov_b32 m0, s14
    s_add_u32 s14, s14, 4096
    buffer_load_dwordx4 v147, s[4:7], s13 offen lds
    s_add_u32 s13, s13, 4096

    s_mov_b32 m0, s14
    s_add_u32 s14, s14, 4096
    buffer_load_dwordx4 v147, s[4:7], s13 offen lds
    s_add_u32 s13, s13, 4096

    s_mov_b32 m0, s14
    s_add_u32 s14, s14, 4096
    buffer_load_dwordx4 v147, s[4:7], s13 offen lds
    s_add_u32 s13, s13, 4096

    s_mov_b32 m0, s14
    s_add_u32 s14, s14, 4096
    buffer_load_dwordx4 v147, s[4:7], s13 offen lds
    s_add_u32 s13, s13, 4096

    s_mov_b32 m0, s14
    s_add_u32 s14, s14, 4096
    buffer_load_dwordx4 v147, s[4:7], s13 offen lds
    s_add_u32 s13, s13, 4096

    v_mov_b32 v14, 0
    v_mov_b32 v15, 0
    v_mov_b32 v22, 0
    v_mov_b32 v23, 0
    v_mov_b32 v30, 0x3f803f80
    v_mov_b32 v31, 0
    v_mov_b32 v38, 0x3f803f80
    v_mov_b32 v39, 0
    s_mul_i32 s20, s12, 40960
    v_lshl_add_u32 v144, v153, 4, s20
    v_and_b32 v148, 31, v153
    v_lshl_add_u32 v145, v148, 3, s20
    v_add_u32 v145, 1024, v145
    v_min_u32 v148, 20, v148
    v_lshlrev_b32 v148, 4, v148
    v_mul_u32_u24 v149, 336, v154
    v_add_u32 v146, v148, v149
    s_mul_i32 s17, s8, 86016
    s_mul_i32 s20, s12, 43008
    s_add_u32 s17, s17, s20
    s_add_u32 s17, s17, 5242880
    s_mov_b32 s16, 1
    s_waitcnt vmcnt(6)
    s_barrier

Lattn_pass1:
    v_mov_b32 v151, 0xff800000
    v_mov_b32 v152, 0xff800000
    v_mov_b32 v147, v144
    v_mov_b32 v148, v145
    v_mov_b32 v14, 0
    v_mov_b32 v22, 0
    s_mov_b32 s15, 0

Lattn_p1loop:
    ds_read_b128 v[24:27], v147
    ds_read_b64 v[28:29], v148
    v_add_u32 v147, 1280, v147
    v_add_u32 v148, 1280, v148
    s_waitcnt lgkmcnt(0)
    v_mfma_f32_32x32x16_bf16 v[64:79], v[24:27], v[8:11], 0
    v_mfma_f32_32x32x16_bf16 v[64:79], v[28:31], v[12:15], v[64:79]
    v_mfma_f32_32x32x16_bf16 v[80:95], v[24:27], v[16:19], 0
    v_mfma_f32_32x32x16_bf16 v[80:95], v[28:31], v[20:23], v[80:95]
    s_nop 15

    v_max3_f32 v151, v64, v65, v151
    v_max3_f32 v151, v66, v67, v151
    v_max3_f32 v151, v68, v69, v151
    v_max3_f32 v151, v70, v71, v151
    v_max3_f32 v151, v72, v73, v151
    v_max3_f32 v151, v74, v75, v151
    v_max3_f32 v151, v76, v77, v151
    v_max3_f32 v151, v78, v79, v151
    v_max3_f32 v152, v80, v81, v152
    v_max3_f32 v152, v82, v83, v152
    v_max3_f32 v152, v84, v85, v152
    v_max3_f32 v152, v86, v87, v152
    v_max3_f32 v152, v88, v89, v152
    v_max3_f32 v152, v90, v91, v152
    v_max3_f32 v152, v92, v93, v152
    v_max3_f32 v152, v94, v95, v152
    s_add_u32 s15, s15, 1
    s_cmp_lt_u32 s15, s16
    s_cbranch_scc1 Lattn_p1loop

    s_lshl_b32 s20, s10, 9
    s_add_u32 s20, s20, 81920
    v_lshl_add_u32 v147, v153, 2, s20
    ds_write_b32 v147, v151
    ds_write_b32 v147, v152 offset:256
    s_waitcnt lgkmcnt(0)
    s_barrier
    s_lshl_b32 s20, s11, 9
    s_add_u32 s20, s20, 81920
    v_and_b32 v147, 31, v153
    v_lshl_add_u32 v147, v147, 2, s20
    ds_read_b32 v156, v147
    ds_read_b32 v157, v147 offset:128
    ds_read_b32 v158, v147 offset:2048
    ds_read_b32 v159, v147 offset:2176
    ds_read_b32 v160, v147 offset:256
    ds_read_b32 v161, v147 offset:384
    ds_read_b32 v162, v147 offset:2304
    ds_read_b32 v163, v147 offset:2432
    s_waitcnt lgkmcnt(0)
    v_max3_f32 v151, v156, v157, v158
    v_max3_f32 v152, v160, v161, v162
    v_max_f32 v151, v151, v159
    v_max_f32 v152, v152, v163

    v_cvt_pk_bf16_f32 v147, v151, v151
    v_lshlrev_b32 v147, 16, v147
    v_sub_f32 v148, v151, v147
    v_cvt_pk_bf16_f32 v147, v147, v148
    v_xor_b32 v147, 0x80008000, v147
    v_cmp_gt_u32 vcc, 32, v153
    s_nop 1
    v_cndmask_b32 v14, 0, v147, vcc

    v_cvt_pk_bf16_f32 v147, v152, v152
    v_lshlrev_b32 v147, 16, v147
    v_sub_f32 v148, v152, v147
    v_cvt_pk_bf16_f32 v147, v147, v148
    v_xor_b32 v147, 0x80008000, v147
    v_cmp_gt_u32 vcc, 32, v153
    s_nop 1
    v_cndmask_b32 v22, 0, v147, vcc

    v_mov_b32 v147, v144
    v_mov_b32 v148, v145
    s_mov_b32 s18, s17
    s_mov_b32 s15, 0

    v_mov_b32 v112, 0
    v_mov_b32 v128, 0
    v_mov_b32 v113, 0
    v_mov_b32 v129, 0
    v_mov_b32 v114, 0
    v_mov_b32 v130, 0
    v_mov_b32 v115, 0
    v_mov_b32 v131, 0
    v_mov_b32 v116, 0
    v_mov_b32 v132, 0
    v_mov_b32 v117, 0
    v_mov_b32 v133, 0
    v_mov_b32 v118, 0
    v_mov_b32 v134, 0
    v_mov_b32 v119, 0
    v_mov_b32 v135, 0
    v_mov_b32 v120, 0
    v_mov_b32 v136, 0
    v_mov_b32 v121, 0
    v_mov_b32 v137, 0
    v_mov_b32 v122, 0
    v_mov_b32 v138, 0
    v_mov_b32 v123, 0
    v_mov_b32 v139, 0
    v_mov_b32 v124, 0
    v_mov_b32 v140, 0
    v_mov_b32 v125, 0
    v_mov_b32 v141, 0
    v_mov_b32 v126, 0
    v_mov_b32 v142, 0
    v_mov_b32 v127, 0
    v_mov_b32 v143, 0
    ds_read_b128 v[24:27], v147
    ds_read_b64 v[28:29], v148
    ds_read_b128 v[32:35], v147 offset:1280
    ds_read_b64 v[36:37], v148 offset:1280
    buffer_load_dwordx4 v[40:43], v146, s[4:7], s18 offen
    buffer_load_dwordx4 v[44:47], v146, s[4:7], s18 offen offset:672
    v_mov_b32 v104, 0
    v_mov_b32 v105, 0
    v_mov_b32 v106, 0
    v_mov_b32 v107, 0
    v_mov_b32 v108, 0
    v_mov_b32 v109, 0
    v_mov_b32 v110, 0
    v_mov_b32 v111, 0
    v_mov_b32 v48, 0
    v_mov_b32 v49, 0
    v_mov_b32 v50, 0
    v_mov_b32 v51, 0
    v_mov_b32 v52, 0
    v_mov_b32 v53, 0
    v_mov_b32 v54, 0
    v_mov_b32 v55, 0
    s_waitcnt lgkmcnt(2)

    v_mfma_f32_32x32x16_bf16 v[64:79], v[24:27], v[8:11], 0
    v_mfma_f32_32x32x16_bf16 v[64:79], v[28:31], v[12:15], v[64:79]
    v_mfma_f32_32x32x16_bf16 v[80:95], v[24:27], v[16:19], 0
    v_mfma_f32_32x32x16_bf16 v[80:95], v[28:31], v[20:23], v[80:95]
Lattn_p2loop:
    s_cmp_lg_u32 s15, 6
    s_cbranch_scc1 Lattn_nosync
    s_waitcnt vmcnt(0)
    s_barrier

Lattn_nosync:
    s_waitcnt lgkmcnt(0)
    v_mfma_f32_32x32x16_bf16 v[128:143], v[48:51], v[104:107], v[128:143]
    ds_read_b128 v[24:27], v147 offset:2560
    ds_read_b64 v[28:29], v148 offset:2560
    v_exp_f32 v64, v64
    v_exp_f32 v65, v65
    v_exp_f32 v66, v66
    v_exp_f32 v67, v67
    v_exp_f32 v68, v68
    v_exp_f32 v69, v69
    v_mfma_f32_32x32x16_bf16 v[128:143], v[52:55], v[108:111], v[128:143]
    buffer_load_dwordx4 v[48:51], v146, s[4:7], s18 offen offset:1344
    buffer_load_dwordx4 v[52:55], v146, s[4:7], s18 offen offset:2016
    v_exp_f32 v70, v70
    v_exp_f32 v71, v71
    v_exp_f32 v72, v72
    v_exp_f32 v73, v73
    v_exp_f32 v74, v74
    v_exp_f32 v75, v75
    v_mfma_f32_32x32x16_bf16 v[172:187], v[32:35], v[8:11], 0
    v_exp_f32 v76, v76
    v_exp_f32 v77, v77
    v_exp_f32 v78, v78
    v_exp_f32 v79, v79
    v_cvt_pk_bf16_f32 v96, v64, v65
    v_cvt_pk_bf16_f32 v97, v66, v67
    v_mfma_f32_32x32x16_bf16 v[172:187], v[36:39], v[12:15], v[172:187]
    v_cvt_pk_bf16_f32 v98, v68, v69
    v_cvt_pk_bf16_f32 v99, v70, v71
    v_cvt_pk_bf16_f32 v100, v72, v73
    v_cvt_pk_bf16_f32 v101, v74, v75
    v_cvt_pk_bf16_f32 v102, v76, v77
    v_cvt_pk_bf16_f32 v103, v78, v79
    v_exp_f32 v80, v80
    v_exp_f32 v81, v81
    s_waitcnt vmcnt(2)
    v_mfma_f32_32x32x16_bf16 v[112:127], v[40:43], v[96:99], v[112:127]
    v_exp_f32 v82, v82
    v_exp_f32 v83, v83
    v_exp_f32 v84, v84
    v_exp_f32 v85, v85
    v_exp_f32 v86, v86
    v_exp_f32 v87, v87
    v_mfma_f32_32x32x16_bf16 v[112:127], v[44:47], v[100:103], v[112:127]
    v_exp_f32 v88, v88
    v_exp_f32 v89, v89
    v_exp_f32 v90, v90
    v_exp_f32 v91, v91
    v_exp_f32 v92, v92
    v_exp_f32 v93, v93
    v_mfma_f32_32x32x16_bf16 v[188:203], v[32:35], v[16:19], 0
    v_exp_f32 v94, v94
    v_exp_f32 v95, v95
    v_cvt_pk_bf16_f32 v104, v80, v81
    v_cvt_pk_bf16_f32 v105, v82, v83
    v_cvt_pk_bf16_f32 v106, v84, v85
    v_cvt_pk_bf16_f32 v107, v86, v87
    v_mfma_f32_32x32x16_bf16 v[188:203], v[36:39], v[20:23], v[188:203]
    v_cvt_pk_bf16_f32 v108, v88, v89
    v_cvt_pk_bf16_f32 v109, v90, v91
    v_cvt_pk_bf16_f32 v110, v92, v93
    v_cvt_pk_bf16_f32 v111, v94, v95
    s_waitcnt lgkmcnt(0)
    v_mfma_f32_32x32x16_bf16 v[128:143], v[40:43], v[104:107], v[128:143]
    ds_read_b128 v[32:35], v147 offset:3840
    ds_read_b64 v[36:37], v148 offset:3840
    v_exp_f32 v172, v172
    v_exp_f32 v173, v173
    v_exp_f32 v174, v174
    v_exp_f32 v175, v175
    v_exp_f32 v176, v176
    v_exp_f32 v177, v177
    v_mfma_f32_32x32x16_bf16 v[128:143], v[44:47], v[108:111], v[128:143]
    buffer_load_dwordx4 v[40:43], v146, s[4:7], s18 offen offset:2688
    buffer_load_dwordx4 v[44:47], v146, s[4:7], s18 offen offset:3360
    v_exp_f32 v178, v178
    v_exp_f32 v179, v179
    v_exp_f32 v180, v180
    v_exp_f32 v181, v181
    v_exp_f32 v182, v182
    v_exp_f32 v183, v183
    v_mfma_f32_32x32x16_bf16 v[64:79], v[24:27], v[8:11], 0
    v_exp_f32 v184, v184
    v_exp_f32 v185, v185
    v_exp_f32 v186, v186
    v_exp_f32 v187, v187
    v_cvt_pk_bf16_f32 v96, v172, v173
    v_cvt_pk_bf16_f32 v97, v174, v175
    v_mfma_f32_32x32x16_bf16 v[64:79], v[28:31], v[12:15], v[64:79]
    v_cvt_pk_bf16_f32 v98, v176, v177
    v_cvt_pk_bf16_f32 v99, v178, v179
    v_cvt_pk_bf16_f32 v100, v180, v181
    v_cvt_pk_bf16_f32 v101, v182, v183
    v_cvt_pk_bf16_f32 v102, v184, v185
    v_cvt_pk_bf16_f32 v103, v186, v187
    v_exp_f32 v188, v188
    v_exp_f32 v189, v189
    s_waitcnt vmcnt(2)
    v_mfma_f32_32x32x16_bf16 v[112:127], v[48:51], v[96:99], v[112:127]
    v_exp_f32 v190, v190
    v_exp_f32 v191, v191
    v_exp_f32 v192, v192
    v_exp_f32 v193, v193
    v_exp_f32 v194, v194
    v_exp_f32 v195, v195
    v_mfma_f32_32x32x16_bf16 v[112:127], v[52:55], v[100:103], v[112:127]
    v_exp_f32 v196, v196
    v_exp_f32 v197, v197
    v_exp_f32 v198, v198
    v_exp_f32 v199, v199
    v_exp_f32 v200, v200
    v_exp_f32 v201, v201
    v_mfma_f32_32x32x16_bf16 v[80:95], v[24:27], v[16:19], 0
    v_exp_f32 v202, v202
    v_exp_f32 v203, v203
    v_cvt_pk_bf16_f32 v104, v188, v189
    v_cvt_pk_bf16_f32 v105, v190, v191
    v_cvt_pk_bf16_f32 v106, v192, v193
    v_cvt_pk_bf16_f32 v107, v194, v195
    v_mfma_f32_32x32x16_bf16 v[80:95], v[28:31], v[20:23], v[80:95]
    v_cvt_pk_bf16_f32 v108, v196, v197
    v_cvt_pk_bf16_f32 v109, v198, v199
    v_cvt_pk_bf16_f32 v110, v200, v201
    v_cvt_pk_bf16_f32 v111, v202, v203
    v_add_u32 v147, 2560, v147
    v_add_u32 v148, 2560, v148
    s_add_u32 s18, s18, 2688
    s_add_u32 s15, s15, 1
    s_cmp_lt_u32 s15, 16
    s_cbranch_scc1 Lattn_p2loop
    s_nop 1

    v_mfma_f32_32x32x16_bf16 v[128:143], v[48:51], v[104:107], v[128:143]
    v_mfma_f32_32x32x16_bf16 v[128:143], v[52:55], v[108:111], v[128:143]
    s_waitcnt vmcnt(0) lgkmcnt(0)
    s_nop 15

    v_mov_b32 v149, 0x5d800000
    v_cmp_nle_f32 vcc, v120, v149
    v_cmp_nle_f32 s[20:21], v136, v149
    s_nop 4
    s_or_b64 s[20:21], s[20:21], vcc
    s_cmp_lg_u64 s[20:21], 0
    s_cselect_b32 s22, 1, 0
    s_lshl_b32 s20, s10, 2
    s_add_u32 s20, s20, 86016
    v_mov_b32 v147, s20
    v_mov_b32 v148, s22
    ds_write_b32 v147, v148
    s_waitcnt lgkmcnt(0)
    s_barrier
    v_mov_b32 v147, 86016
    ds_read_b128 v[156:159], v147
    ds_read_b128 v[160:163], v147 offset:16
    s_waitcnt lgkmcnt(0)
    v_or3_b32 v147, v156, v157, v158
    v_or3_b32 v147, v147, v159, v160
    v_or3_b32 v147, v147, v161, v162
    v_or_b32 v147, v147, v163
    s_nop 1
    v_readfirstlane_b32 s22, v147
    s_nop 3
    s_nop 0
    s_cmp_eq_u32 s22, 0
    s_cbranch_scc1 Lattn_ok
    s_cmp_eq_u32 s16, 32
    s_cbranch_scc1 Lattn_ok
    s_mov_b32 s16, 32
    s_barrier
    s_branch Lattn_pass1

Lattn_ok:
    s_lshl_b32 s20, s11, 1
    s_mul_i32 s20, s20, 3072
    s_add_u32 s20, s20, 86272
    v_lshl_add_u32 v147, v153, 4, s20
    s_cmp_eq_u32 s12, 0
    s_cbranch_scc1 Lattn_rd

    ds_write_b128 v147, v[112:115] offset:0
    ds_write_b128 v147, v[116:119] offset:1024
    ds_write_b128 v147, v[120:123] offset:2048
    ds_write_b128 v147, v[128:131] offset:3072
    ds_write_b128 v147, v[132:135] offset:4096
    ds_write_b128 v147, v[136:139] offset:5120
    s_waitcnt lgkmcnt(0)
    s_barrier
    s_branch Lattn_fin

Lattn_rd:
    s_barrier
    s_nop 0
    ds_read_b128 v[156:159], v147 offset:0
    ds_read_b128 v[160:163], v147 offset:1024
    ds_read_b128 v[164:167], v147 offset:2048
    s_waitcnt lgkmcnt(0)
    v_add_f32 v112, v112, v156
    v_add_f32 v113, v113, v157
    v_add_f32 v114, v114, v158
    v_add_f32 v115, v115, v159
    v_add_f32 v116, v116, v160
    v_add_f32 v117, v117, v161
    v_add_f32 v118, v118, v162
    v_add_f32 v119, v119, v163
    v_add_f32 v120, v120, v164
    v_add_f32 v121, v121, v165
    v_add_f32 v122, v122, v166
    v_add_f32 v123, v123, v167
    ds_read_b128 v[156:159], v147 offset:3072
    ds_read_b128 v[160:163], v147 offset:4096
    ds_read_b128 v[164:167], v147 offset:5120
    s_waitcnt lgkmcnt(0)
    v_add_f32 v128, v128, v156
    v_add_f32 v129, v129, v157
    v_add_f32 v130, v130, v158
    v_add_f32 v131, v131, v159
    v_add_f32 v132, v132, v160
    v_add_f32 v133, v133, v161
    v_add_f32 v134, v134, v162
    v_add_f32 v135, v135, v163
    v_add_f32 v136, v136, v164
    v_add_f32 v137, v137, v165
    v_add_f32 v138, v138, v166
    v_add_f32 v139, v139, v167
    s_lshl_b32 s20, s9, 8
    s_lshl_b32 s21, s11, 6
    s_add_u32 s20, s20, s21
    s_mul_i32 s20, s20, 1280
    s_mul_i32 s21, s8, 40
    s_add_u32 s20, s20, s21
    s_add_u32 s20, s20, 7995392
    v_and_b32 v147, 31, v153
    v_mul_u32_u24 v147, 1280, v147
    v_lshl_add_u32 v147, v154, 3, v147
    v_mov_b32 v148, 0x80000000
    v_cmp_gt_u32 vcc, 32, v153
    s_nop 1
    v_cndmask_b32 v148, v148, v147, vcc

    v_mov_b32 v149, v120
    v_mov_b32 v150, v120
    s_nop 1
    v_permlane32_swap_b32 v149, v150
    s_nop 1
    v_rcp_f32 v150, v150
    s_nop 1

    v_mul_f32 v112, v112, v150
    v_mul_f32 v113, v113, v150
    v_mul_f32 v114, v114, v150
    v_mul_f32 v115, v115, v150
    v_mul_f32 v116, v116, v150
    v_mul_f32 v117, v117, v150
    v_mul_f32 v118, v118, v150
    v_mul_f32 v119, v119, v150
    v_mul_f32 v120, v120, v150
    v_mul_f32 v121, v121, v150
    v_mul_f32 v122, v122, v150
    v_mul_f32 v123, v123, v150
    v_cvt_pk_bf16_f32 v156, v112, v113
    v_cvt_pk_bf16_f32 v157, v114, v115
    v_cvt_pk_bf16_f32 v158, v116, v117
    v_cvt_pk_bf16_f32 v159, v118, v119
    v_cvt_pk_bf16_f32 v160, v120, v121
    v_cvt_pk_bf16_f32 v161, v122, v123
    buffer_store_dwordx2 v[156:157], v147, s[4:7], s20 offen
    buffer_store_dwordx2 v[158:159], v147, s[4:7], s20 offen offset:16
    buffer_store_dwordx2 v[160:161], v148, s[4:7], s20 offen offset:32
    s_add_u32 s20, s20, 40960

    v_mov_b32 v149, v136
    v_mov_b32 v150, v136
    s_nop 1
    v_permlane32_swap_b32 v149, v150
    s_nop 1
    v_rcp_f32 v150, v150
    s_nop 1

    v_mul_f32 v128, v128, v150
    v_mul_f32 v129, v129, v150
    v_mul_f32 v130, v130, v150
    v_mul_f32 v131, v131, v150
    v_mul_f32 v132, v132, v150
    v_mul_f32 v133, v133, v150
    v_mul_f32 v134, v134, v150
    v_mul_f32 v135, v135, v150
    v_mul_f32 v136, v136, v150
    v_mul_f32 v137, v137, v150
    v_mul_f32 v138, v138, v150
    v_mul_f32 v139, v139, v150
    v_cvt_pk_bf16_f32 v156, v128, v129
    v_cvt_pk_bf16_f32 v157, v130, v131
    v_cvt_pk_bf16_f32 v158, v132, v133
    v_cvt_pk_bf16_f32 v159, v134, v135
    v_cvt_pk_bf16_f32 v160, v136, v137
    v_cvt_pk_bf16_f32 v161, v138, v139
    buffer_store_dwordx2 v[156:157], v147, s[4:7], s20 offen
    buffer_store_dwordx2 v[158:159], v147, s[4:7], s20 offen offset:16
    buffer_store_dwordx2 v[160:161], v148, s[4:7], s20 offen offset:32
    s_add_u32 s20, s20, 40960

Lattn_fin:
Lattn_end:
    s_endpgm
    .globl outp_kernel
    .p2align 8
    .type outp_kernel,@function
outp_kernel:
    s_cmp_ge_u32 s2, 256
    s_cbranch_scc1 Lout_end

    s_load_dwordx2 s[4:5], s[0:1], 40
    s_load_dwordx2 s[8:9], s[0:1], 16
    s_load_dwordx2 s[12:13], s[0:1], 24
    v_and_b32 v1, 63, v0
    v_lshrrev_b32 v2, 6, v0
    s_and_b32 s20, s2, 7
    s_lshl_b32 s20, s20, 3
    s_bfe_u32 s21, s2, 0x30003
    s_add_u32 s16, s20, s21
    s_lshr_b32 s17, s2, 6
    v_readfirstlane_b32 s18, v2
    s_mov_b32 s6, 10616832
    s_mov_b32 s7, 0x00020000
    s_mov_b32 s10, 819200
    s_mov_b32 s11, 0x00020000
    s_mov_b32 s14, 2621440
    s_mov_b32 s15, 0x00020000
    s_and_b32 s19, s18, 1
    s_lshr_b32 s24, s18, 1
    v_lshrrev_b32 v2, 4, v1
    v_and_b32 v3, 15, v1
    v_and_b32 v4, 7, v1
    v_lshrrev_b32 v5, 3, v1

    s_add_u32 s20, s18, 0
    s_lshl_b32 s20, s20, 3
    v_add_u32 v96, s20, v5
    v_bfe_u32 v97, v96, 1, 3
    v_xor_b32 v97, v97, v4
    v_mul_u32_u24 v96, 1280, v96
    v_lshl_add_u32 v90, v97, 4, v96

    s_add_u32 s20, s18, 0
    s_lshl_b32 s20, s20, 10
    v_lshl_add_u32 v96, v1, 4, s20
    v_mul_u32_u24 v97, 52429, v96
    v_lshrrev_b32 v97, 24, v97
    v_mul_u32_u24 v98, 320, v97
    v_sub_u32 v98, v96, v98
    v_lshrrev_b32 v98, 4, v98
    v_bfe_u32 v99, v97, 3, 1
    v_lshlrev_b32 v99, 1, v99
    v_xor_b32 v98, v98, v99
    v_mul_u32_u24 v97, 1280, v97
    v_lshl_add_u32 v91, v98, 4, v97

    s_add_u32 s20, s18, 4
    s_lshl_b32 s20, s20, 10
    v_lshl_add_u32 v96, v1, 4, s20
    v_mul_u32_u24 v97, 52429, v96
    v_lshrrev_b32 v97, 24, v97
    v_mul_u32_u24 v98, 320, v97
    v_sub_u32 v98, v96, v98
    v_lshrrev_b32 v98, 4, v98
    v_bfe_u32 v99, v97, 3, 1
    v_lshlrev_b32 v99, 1, v99
    v_xor_b32 v98, v98, v99
    v_mul_u32_u24 v97, 1280, v97
    v_lshl_add_u32 v92, v98, 4, v97

    s_add_u32 s20, s18, 8
    s_lshl_b32 s20, s20, 10
    v_lshl_add_u32 v96, v1, 4, s20
    v_mul_u32_u24 v97, 52429, v96
    v_lshrrev_b32 v97, 24, v97
    v_mul_u32_u24 v98, 320, v97
    v_sub_u32 v98, v96, v98
    v_lshrrev_b32 v98, 4, v98
    v_bfe_u32 v99, v97, 3, 1
    v_lshlrev_b32 v99, 1, v99
    v_xor_b32 v98, v98, v99
    v_mul_u32_u24 v97, 1280, v97
    v_lshl_add_u32 v93, v98, 4, v97

    s_add_u32 s20, s18, 12
    s_lshl_b32 s20, s20, 10
    v_lshl_add_u32 v96, v1, 4, s20
    v_mul_u32_u24 v97, 52429, v96
    v_lshrrev_b32 v97, 24, v97
    v_mul_u32_u24 v98, 320, v97
    v_sub_u32 v98, v96, v98
    v_lshrrev_b32 v98, 4, v98
    v_bfe_u32 v99, v97, 3, 1
    v_lshlrev_b32 v99, 1, v99
    v_xor_b32 v98, v98, v99
    v_mul_u32_u24 v97, 1280, v97
    v_lshl_add_u32 v94, v98, 4, v97

    s_add_u32 s20, s18, 16
    s_lshl_b32 s20, s20, 10
    v_lshl_add_u32 v96, v1, 4, s20
    v_mul_u32_u24 v97, 52429, v96
    v_lshrrev_b32 v97, 24, v97
    v_mul_u32_u24 v98, 320, v97
    v_sub_u32 v98, v96, v98
    v_lshrrev_b32 v98, 4, v98
    v_bfe_u32 v99, v97, 3, 1
    v_lshlrev_b32 v99, 1, v99
    v_xor_b32 v98, v98, v99
    v_mul_u32_u24 v97, 1280, v97
    v_lshl_add_u32 v95, v98, 4, v97

    s_mul_i32 s21, s16, 40960
    s_add_u32 s21, s21, 7995392
    s_mul_i32 s22, s17, 320
    s_lshl_b32 s27, s18, 10
    s_waitcnt lgkmcnt(0)

    s_mov_b32 s28, 0
    s_add_u32 s20, s28, s27
    s_add_u32 m0, s20, 0
    buffer_load_dwordx4 v90, s[4:7], s21 offen lds

    s_add_u32 s20, s28, s27
    s_add_u32 m0, s20, 4096
    buffer_load_dwordx4 v91, s[8:11], s22 offen lds

    s_add_u32 s20, s28, s27
    s_add_u32 m0, s20, 8192
    buffer_load_dwordx4 v92, s[8:11], s22 offen lds

    s_add_u32 s20, s28, s27
    s_add_u32 m0, s20, 12288
    buffer_load_dwordx4 v93, s[8:11], s22 offen lds

    s_add_u32 s20, s28, s27
    s_add_u32 m0, s20, 16384
    buffer_load_dwordx4 v94, s[8:11], s22 offen lds

    s_add_u32 s20, s28, s27
    s_add_u32 m0, s20, 20480
    buffer_load_dwordx4 v95, s[8:11], s22 offen lds

    s_add_u32 s28, s28, 24576
    s_add_u32 s21, s21, 128
    s_add_u32 s22, s22, 81920

    s_add_u32 s20, s28, s27
    s_add_u32 m0, s20, 0
    buffer_load_dwordx4 v90, s[4:7], s21 offen lds

    s_add_u32 s20, s28, s27
    s_add_u32 m0, s20, 4096
    buffer_load_dwordx4 v91, s[8:11], s22 offen lds

    s_add_u32 s20, s28, s27
    s_add_u32 m0, s20, 8192
    buffer_load_dwordx4 v92, s[8:11], s22 offen lds

    s_add_u32 s20, s28, s27
    s_add_u32 m0, s20, 12288
    buffer_load_dwordx4 v93, s[8:11], s22 offen lds

    s_add_u32 s20, s28, s27
    s_add_u32 m0, s20, 16384
    buffer_load_dwordx4 v94, s[8:11], s22 offen lds

    s_add_u32 s20, s28, s27
    s_add_u32 m0, s20, 20480
    buffer_load_dwordx4 v95, s[8:11], s22 offen lds

    s_add_u32 s28, s28, 24576
    s_add_u32 s21, s21, 128
    s_add_u32 s22, s22, 81920

    s_add_u32 s20, s28, s27
    s_add_u32 m0, s20, 0
    buffer_load_dwordx4 v90, s[4:7], s21 offen lds

    s_add_u32 s20, s28, s27
    s_add_u32 m0, s20, 4096
    buffer_load_dwordx4 v91, s[8:11], s22 offen lds

    s_add_u32 s20, s28, s27
    s_add_u32 m0, s20, 8192
    buffer_load_dwordx4 v92, s[8:11], s22 offen lds

    s_add_u32 s20, s28, s27
    s_add_u32 m0, s20, 12288
    buffer_load_dwordx4 v93, s[8:11], s22 offen lds

    s_add_u32 s20, s28, s27
    s_add_u32 m0, s20, 16384
    buffer_load_dwordx4 v94, s[8:11], s22 offen lds

    s_add_u32 s20, s28, s27
    s_add_u32 m0, s20, 20480
    buffer_load_dwordx4 v95, s[8:11], s22 offen lds

    s_add_u32 s28, s28, 24576
    s_add_u32 s21, s21, 128
    s_add_u32 s22, s22, 81920

    s_mul_i32 s20, s19, 16
    v_add_u32 v96, s20, v3
    v_add_u32 v96, 0, v96
    v_bfe_u32 v97, v96, 1, 3
    v_lshlrev_b32 v96, 7, v96
    v_xor_b32 v98, v97, v2
    v_lshl_add_u32 v76, v98, 4, v96
    v_xor_b32 v97, 4, v97
    v_xor_b32 v98, v97, v2
    v_lshl_add_u32 v77, v98, 4, v96

    v_lshlrev_b32 v100, 3, v2
    v_bfe_u32 v99, v1, 2, 2
    v_add_u32 v100, v100, v99
    v_mul_u32_u24 v100, 320, v100
    v_and_b32 v101, 1, v2
    v_lshlrev_b32 v101, 1, v101
    v_and_b32 v99, 3, v1
    v_lshlrev_b32 v99, 2, v99
    s_mul_i32 s20, s24, 80
    v_add_u32 v99, s20, v99
    v_add_u32 v100, 4096, v100

    v_add_u32 v96, 0, v99
    v_lshrrev_b32 v97, 3, v96
    v_xor_b32 v97, v97, v101
    v_and_b32 v96, 7, v96
    v_lshl_add_u32 v96, v96, 1, v100
    v_lshl_add_u32 v78, v97, 4, v96

    v_add_u32 v96, 16, v99
    v_lshrrev_b32 v97, 3, v96
    v_xor_b32 v97, v97, v101
    v_and_b32 v96, 7, v96
    v_lshl_add_u32 v96, v96, 1, v100
    v_lshl_add_u32 v79, v97, 4, v96

    v_add_u32 v96, 32, v99
    v_lshrrev_b32 v97, 3, v96
    v_xor_b32 v97, v97, v101
    v_and_b32 v96, 7, v96
    v_lshl_add_u32 v96, v96, 1, v100
    v_lshl_add_u32 v80, v97, 4, v96

    v_add_u32 v96, 48, v99
    v_lshrrev_b32 v97, 3, v96
    v_xor_b32 v97, v97, v101
    v_and_b32 v96, 7, v96
    v_lshl_add_u32 v96, v96, 1, v100
    v_lshl_add_u32 v81, v97, 4, v96

    v_add_u32 v96, 64, v99
    v_lshrrev_b32 v97, 3, v96
    v_xor_b32 v97, v97, v101
    v_and_b32 v96, 7, v96
    v_lshl_add_u32 v96, v96, 1, v100
    v_lshl_add_u32 v82, v97, 4, v96

    v_mov_b32 v8, 0
    v_mov_b32 v9, 0
    v_mov_b32 v10, 0
    v_mov_b32 v11, 0
    v_mov_b32 v12, 0
    v_mov_b32 v13, 0
    v_mov_b32 v14, 0
    v_mov_b32 v15, 0
    v_mov_b32 v16, 0
    v_mov_b32 v17, 0
    v_mov_b32 v18, 0
    v_mov_b32 v19, 0
    v_mov_b32 v20, 0
    v_mov_b32 v21, 0
    v_mov_b32 v22, 0
    v_mov_b32 v23, 0
    v_mov_b32 v24, 0
    v_mov_b32 v25, 0
    v_mov_b32 v26, 0
    v_mov_b32 v27, 0
    s_mov_b32 s29, 0
    s_mov_b32 s30, 24576
    s_mov_b32 s28, 73728
    s_mov_b32 s31, 0
    s_waitcnt vmcnt(12)
    s_barrier

    v_add_u32 v83, s29, v76
    v_add_u32 v85, s29, v78
    v_add_u32 v86, s29, v79
    v_add_u32 v87, s29, v80
    v_add_u32 v88, s29, v81
    v_add_u32 v89, s29, v82
    ds_read_b128 v[28:31], v83
    ds_read_b64_tr_b16 v[32:33], v85 offset:0
    ds_read_b64_tr_b16 v[34:35], v85 offset:1280
    ds_read_b64_tr_b16 v[36:37], v86 offset:0
    ds_read_b64_tr_b16 v[38:39], v86 offset:1280
    ds_read_b64_tr_b16 v[40:41], v87 offset:0
    ds_read_b64_tr_b16 v[42:43], v87 offset:1280
    ds_read_b64_tr_b16 v[44:45], v88 offset:0
    ds_read_b64_tr_b16 v[46:47], v88 offset:1280
    ds_read_b64_tr_b16 v[48:49], v89 offset:0
    ds_read_b64_tr_b16 v[50:51], v89 offset:1280
Lout_loopa:
    s_waitcnt vmcnt(6)
    s_barrier
    s_add_u32 s20, s28, s27
    s_add_u32 m0, s20, 0
    buffer_load_dwordx4 v90, s[4:7], s21 offen lds

    s_add_u32 s20, s28, s27
    s_add_u32 m0, s20, 4096
    buffer_load_dwordx4 v91, s[8:11], s22 offen lds

    s_add_u32 s20, s28, s27
    s_add_u32 m0, s20, 8192
    buffer_load_dwordx4 v92, s[8:11], s22 offen lds

    s_add_u32 s20, s28, s27
    s_add_u32 m0, s20, 12288
    buffer_load_dwordx4 v93, s[8:11], s22 offen lds

    s_add_u32 s20, s28, s27
    s_add_u32 m0, s20, 16384
    buffer_load_dwordx4 v94, s[8:11], s22 offen lds

    s_add_u32 s20, s28, s27
    s_add_u32 m0, s20, 20480
    buffer_load_dwordx4 v95, s[8:11], s22 offen lds

    v_add_u32 v83, s29, v77
    v_add_u32 v85, s29, v78
    v_add_u32 v86, s29, v79
    v_add_u32 v87, s29, v80
    v_add_u32 v88, s29, v81
    v_add_u32 v89, s29, v82
    ds_read_b128 v[52:55], v83
    ds_read_b64_tr_b16 v[56:57], v85 offset:10240
    ds_read_b64_tr_b16 v[58:59], v85 offset:11520
    ds_read_b64_tr_b16 v[60:61], v86 offset:10240
    ds_read_b64_tr_b16 v[62:63], v86 offset:11520
    ds_read_b64_tr_b16 v[64:65], v87 offset:10240
    ds_read_b64_tr_b16 v[66:67], v87 offset:11520
    ds_read_b64_tr_b16 v[68:69], v88 offset:10240
    ds_read_b64_tr_b16 v[70:71], v88 offset:11520
    ds_read_b64_tr_b16 v[72:73], v89 offset:10240
    ds_read_b64_tr_b16 v[74:75], v89 offset:11520
    s_waitcnt lgkmcnt(11)
    v_mfma_f32_16x16x32_bf16 v[8:11], v[32:35], v[28:31], v[8:11]
    v_mfma_f32_16x16x32_bf16 v[12:15], v[36:39], v[28:31], v[12:15]
    v_mfma_f32_16x16x32_bf16 v[16:19], v[40:43], v[28:31], v[16:19]
    v_mfma_f32_16x16x32_bf16 v[20:23], v[44:47], v[28:31], v[20:23]
    v_mfma_f32_16x16x32_bf16 v[24:27], v[48:51], v[28:31], v[24:27]
    v_add_u32 v83, s30, v76
    v_add_u32 v85, s30, v78
    v_add_u32 v86, s30, v79
    v_add_u32 v87, s30, v80
    v_add_u32 v88, s30, v81
    v_add_u32 v89, s30, v82
    ds_read_b128 v[28:31], v83
    ds_read_b64_tr_b16 v[32:33], v85 offset:0
    ds_read_b64_tr_b16 v[34:35], v85 offset:1280
    ds_read_b64_tr_b16 v[36:37], v86 offset:0
    ds_read_b64_tr_b16 v[38:39], v86 offset:1280
    ds_read_b64_tr_b16 v[40:41], v87 offset:0
    ds_read_b64_tr_b16 v[42:43], v87 offset:1280
    ds_read_b64_tr_b16 v[44:45], v88 offset:0
    ds_read_b64_tr_b16 v[46:47], v88 offset:1280
    ds_read_b64_tr_b16 v[48:49], v89 offset:0
    ds_read_b64_tr_b16 v[50:51], v89 offset:1280
    s_waitcnt lgkmcnt(11)
    v_mfma_f32_16x16x32_bf16 v[8:11], v[56:59], v[52:55], v[8:11]
    v_mfma_f32_16x16x32_bf16 v[12:15], v[60:63], v[52:55], v[12:15]
    v_mfma_f32_16x16x32_bf16 v[16:19], v[64:67], v[52:55], v[16:19]
    v_mfma_f32_16x16x32_bf16 v[20:23], v[68:71], v[52:55], v[20:23]
    v_mfma_f32_16x16x32_bf16 v[24:27], v[72:75], v[52:55], v[24:27]
    s_mov_b32 s29, s30
    s_add_u32 s30, s30, 24576
    s_cmp_eq_u32 s30, 98304
    s_cselect_b32 s30, 0, s30
    s_add_u32 s28, s28, 24576
    s_cmp_eq_u32 s28, 98304
    s_cselect_b32 s28, 0, s28
    s_add_u32 s21, s21, 128
    s_add_u32 s22, s22, 81920

    s_add_u32 s31, s31, 1
    s_cmp_lt_u32 s31, 7
    s_cbranch_scc1 Lout_loopa

    s_waitcnt vmcnt(6)
    s_barrier
    v_add_u32 v83, s29, v77
    v_add_u32 v85, s29, v78
    v_add_u32 v86, s29, v79
    v_add_u32 v87, s29, v80
    v_add_u32 v88, s29, v81
    v_add_u32 v89, s29, v82
    ds_read_b128 v[52:55], v83
    ds_read_b64_tr_b16 v[56:57], v85 offset:10240
    ds_read_b64_tr_b16 v[58:59], v85 offset:11520
    ds_read_b64_tr_b16 v[60:61], v86 offset:10240
    ds_read_b64_tr_b16 v[62:63], v86 offset:11520
    ds_read_b64_tr_b16 v[64:65], v87 offset:10240
    ds_read_b64_tr_b16 v[66:67], v87 offset:11520
    ds_read_b64_tr_b16 v[68:69], v88 offset:10240
    ds_read_b64_tr_b16 v[70:71], v88 offset:11520
    ds_read_b64_tr_b16 v[72:73], v89 offset:10240
    ds_read_b64_tr_b16 v[74:75], v89 offset:11520
    s_waitcnt lgkmcnt(11)
    v_mfma_f32_16x16x32_bf16 v[8:11], v[32:35], v[28:31], v[8:11]
    v_mfma_f32_16x16x32_bf16 v[12:15], v[36:39], v[28:31], v[12:15]
    v_mfma_f32_16x16x32_bf16 v[16:19], v[40:43], v[28:31], v[16:19]
    v_mfma_f32_16x16x32_bf16 v[20:23], v[44:47], v[28:31], v[20:23]
    v_mfma_f32_16x16x32_bf16 v[24:27], v[48:51], v[28:31], v[24:27]
    v_add_u32 v83, s30, v76
    v_add_u32 v85, s30, v78
    v_add_u32 v86, s30, v79
    v_add_u32 v87, s30, v80
    v_add_u32 v88, s30, v81
    v_add_u32 v89, s30, v82
    ds_read_b128 v[28:31], v83
    ds_read_b64_tr_b16 v[32:33], v85 offset:0
    ds_read_b64_tr_b16 v[34:35], v85 offset:1280
    ds_read_b64_tr_b16 v[36:37], v86 offset:0
    ds_read_b64_tr_b16 v[38:39], v86 offset:1280
    ds_read_b64_tr_b16 v[40:41], v87 offset:0
    ds_read_b64_tr_b16 v[42:43], v87 offset:1280
    ds_read_b64_tr_b16 v[44:45], v88 offset:0
    ds_read_b64_tr_b16 v[46:47], v88 offset:1280
    ds_read_b64_tr_b16 v[48:49], v89 offset:0
    ds_read_b64_tr_b16 v[50:51], v89 offset:1280
    s_waitcnt lgkmcnt(11)
    v_mfma_f32_16x16x32_bf16 v[8:11], v[56:59], v[52:55], v[8:11]
    v_mfma_f32_16x16x32_bf16 v[12:15], v[60:63], v[52:55], v[12:15]
    v_mfma_f32_16x16x32_bf16 v[16:19], v[64:67], v[52:55], v[16:19]
    v_mfma_f32_16x16x32_bf16 v[20:23], v[68:71], v[52:55], v[20:23]
    v_mfma_f32_16x16x32_bf16 v[24:27], v[72:75], v[52:55], v[24:27]
    s_mov_b32 s29, s30
    s_add_u32 s30, s30, 24576
    s_cmp_eq_u32 s30, 98304
    s_cselect_b32 s30, 0, s30
    s_add_u32 s28, s28, 24576
    s_cmp_eq_u32 s28, 98304
    s_cselect_b32 s28, 0, s28
    s_add_u32 s21, s21, 128
    s_add_u32 s22, s22, 81920

    s_waitcnt vmcnt(0)
    s_barrier
    v_add_u32 v83, s29, v77
    v_add_u32 v85, s29, v78
    v_add_u32 v86, s29, v79
    v_add_u32 v87, s29, v80
    v_add_u32 v88, s29, v81
    v_add_u32 v89, s29, v82
    ds_read_b128 v[52:55], v83
    ds_read_b64_tr_b16 v[56:57], v85 offset:10240
    ds_read_b64_tr_b16 v[58:59], v85 offset:11520
    ds_read_b64_tr_b16 v[60:61], v86 offset:10240
    ds_read_b64_tr_b16 v[62:63], v86 offset:11520
    ds_read_b64_tr_b16 v[64:65], v87 offset:10240
    ds_read_b64_tr_b16 v[66:67], v87 offset:11520
    ds_read_b64_tr_b16 v[68:69], v88 offset:10240
    ds_read_b64_tr_b16 v[70:71], v88 offset:11520
    ds_read_b64_tr_b16 v[72:73], v89 offset:10240
    ds_read_b64_tr_b16 v[74:75], v89 offset:11520
    s_waitcnt lgkmcnt(11)
    v_mfma_f32_16x16x32_bf16 v[8:11], v[32:35], v[28:31], v[8:11]
    v_mfma_f32_16x16x32_bf16 v[12:15], v[36:39], v[28:31], v[12:15]
    v_mfma_f32_16x16x32_bf16 v[16:19], v[40:43], v[28:31], v[16:19]
    v_mfma_f32_16x16x32_bf16 v[20:23], v[44:47], v[28:31], v[20:23]
    v_mfma_f32_16x16x32_bf16 v[24:27], v[48:51], v[28:31], v[24:27]
    v_add_u32 v83, s30, v76
    v_add_u32 v85, s30, v78
    v_add_u32 v86, s30, v79
    v_add_u32 v87, s30, v80
    v_add_u32 v88, s30, v81
    v_add_u32 v89, s30, v82
    ds_read_b128 v[28:31], v83
    ds_read_b64_tr_b16 v[32:33], v85 offset:0
    ds_read_b64_tr_b16 v[34:35], v85 offset:1280
    ds_read_b64_tr_b16 v[36:37], v86 offset:0
    ds_read_b64_tr_b16 v[38:39], v86 offset:1280
    ds_read_b64_tr_b16 v[40:41], v87 offset:0
    ds_read_b64_tr_b16 v[42:43], v87 offset:1280
    ds_read_b64_tr_b16 v[44:45], v88 offset:0
    ds_read_b64_tr_b16 v[46:47], v88 offset:1280
    ds_read_b64_tr_b16 v[48:49], v89 offset:0
    ds_read_b64_tr_b16 v[50:51], v89 offset:1280
    s_waitcnt lgkmcnt(11)
    v_mfma_f32_16x16x32_bf16 v[8:11], v[56:59], v[52:55], v[8:11]
    v_mfma_f32_16x16x32_bf16 v[12:15], v[60:63], v[52:55], v[12:15]
    v_mfma_f32_16x16x32_bf16 v[16:19], v[64:67], v[52:55], v[16:19]
    v_mfma_f32_16x16x32_bf16 v[20:23], v[68:71], v[52:55], v[20:23]
    v_mfma_f32_16x16x32_bf16 v[24:27], v[72:75], v[52:55], v[24:27]
    s_mov_b32 s29, s30
    s_add_u32 s30, s30, 24576
    s_cmp_eq_u32 s30, 98304
    s_cselect_b32 s30, 0, s30
    s_add_u32 s28, s28, 24576
    s_cmp_eq_u32 s28, 98304
    s_cselect_b32 s28, 0, s28
    s_add_u32 s21, s21, 128
    s_add_u32 s22, s22, 81920

    v_add_u32 v83, s29, v77
    v_add_u32 v85, s29, v78
    v_add_u32 v86, s29, v79
    v_add_u32 v87, s29, v80
    v_add_u32 v88, s29, v81
    v_add_u32 v89, s29, v82
    ds_read_b128 v[52:55], v83
    ds_read_b64_tr_b16 v[56:57], v85 offset:10240
    ds_read_b64_tr_b16 v[58:59], v85 offset:11520
    ds_read_b64_tr_b16 v[60:61], v86 offset:10240
    ds_read_b64_tr_b16 v[62:63], v86 offset:11520
    ds_read_b64_tr_b16 v[64:65], v87 offset:10240
    ds_read_b64_tr_b16 v[66:67], v87 offset:11520
    ds_read_b64_tr_b16 v[68:69], v88 offset:10240
    ds_read_b64_tr_b16 v[70:71], v88 offset:11520
    ds_read_b64_tr_b16 v[72:73], v89 offset:10240
    ds_read_b64_tr_b16 v[74:75], v89 offset:11520
    s_waitcnt lgkmcnt(11)
    v_mfma_f32_16x16x32_bf16 v[8:11], v[32:35], v[28:31], v[8:11]
    v_mfma_f32_16x16x32_bf16 v[12:15], v[36:39], v[28:31], v[12:15]
    v_mfma_f32_16x16x32_bf16 v[16:19], v[40:43], v[28:31], v[16:19]
    v_mfma_f32_16x16x32_bf16 v[20:23], v[44:47], v[28:31], v[20:23]
    v_mfma_f32_16x16x32_bf16 v[24:27], v[48:51], v[28:31], v[24:27]
    s_waitcnt lgkmcnt(0)
    v_mfma_f32_16x16x32_bf16 v[8:11], v[56:59], v[52:55], v[8:11]
    v_mfma_f32_16x16x32_bf16 v[12:15], v[60:63], v[52:55], v[12:15]
    v_mfma_f32_16x16x32_bf16 v[16:19], v[64:67], v[52:55], v[16:19]
    v_mfma_f32_16x16x32_bf16 v[20:23], v[68:71], v[52:55], v[20:23]
    v_mfma_f32_16x16x32_bf16 v[24:27], v[72:75], v[52:55], v[24:27]
    s_nop 15
    s_nop 7
    s_mul_i32 s20, s16, 40960
    s_mul_i32 s21, s19, 20480
    s_add_u32 s20, s20, s21
    s_mul_i32 s21, s17, 320
    s_add_u32 s20, s20, s21
    s_mul_i32 s21, s24, 160
    s_add_u32 s20, s20, s21
    v_mul_u32_u24 v96, 1280, v3
    v_lshl_add_u32 v96, v2, 3, v96

    v_cvt_pk_bf16_f32 v102, v8, v9
    v_cvt_pk_bf16_f32 v103, v10, v11
    buffer_store_dwordx2 v[102:103], v96, s[12:15], s20 offen offset:0
    s_nop 1
    v_cvt_pk_bf16_f32 v102, v12, v13
    v_cvt_pk_bf16_f32 v103, v14, v15
    buffer_store_dwordx2 v[102:103], v96, s[12:15], s20 offen offset:32
    s_nop 1
    v_cvt_pk_bf16_f32 v102, v16, v17
    v_cvt_pk_bf16_f32 v103, v18, v19
    buffer_store_dwordx2 v[102:103], v96, s[12:15], s20 offen offset:64
    s_nop 1
    v_cvt_pk_bf16_f32 v102, v20, v21
    v_cvt_pk_bf16_f32 v103, v22, v23
    buffer_store_dwordx2 v[102:103], v96, s[12:15], s20 offen offset:96
    s_nop 1
    v_cvt_pk_bf16_f32 v102, v24, v25
    v_cvt_pk_bf16_f32 v103, v26, v27
    buffer_store_dwordx2 v[102:103], v96, s[12:15], s20 offen offset:128
    s_nop 1
Lout_fin:
Lout_end:
    s_endpgm
.section .rodata,"a"
.p2align 6
.amdhsa_kernel qkv_kernel
  .amdhsa_next_free_vgpr 144
  .amdhsa_next_free_sgpr 64
  .amdhsa_accum_offset 144
  .amdhsa_group_segment_fixed_size 0
  .amdhsa_kernarg_size 48
  .amdhsa_user_sgpr_count 2
  .amdhsa_user_sgpr_kernarg_segment_ptr 1
  .amdhsa_system_sgpr_workgroup_id_x 1
.end_amdhsa_kernel
.amdhsa_kernel attn_kernel
  .amdhsa_next_free_vgpr 208
  .amdhsa_next_free_sgpr 64
  .amdhsa_accum_offset 208
  .amdhsa_group_segment_fixed_size 0
  .amdhsa_kernarg_size 48
  .amdhsa_user_sgpr_count 2
  .amdhsa_user_sgpr_kernarg_segment_ptr 1
  .amdhsa_system_sgpr_workgroup_id_x 1
.end_amdhsa_kernel
.amdhsa_kernel outp_kernel
  .amdhsa_next_free_vgpr 112
  .amdhsa_next_free_sgpr 64
  .amdhsa_accum_offset 112
  .amdhsa_group_segment_fixed_size 0
  .amdhsa_kernarg_size 48
  .amdhsa_user_sgpr_count 2
  .amdhsa_user_sgpr_kernarg_segment_ptr 1
  .amdhsa_system_sgpr_workgroup_id_x 1
.end_amdhsa_kernel
```
